```python
import torch

def _softmax(x, axis=-1):
    return torch.softmax(x, dim=axis)
def _gelu(x):
    return torch.nn.functional.gelu(x, approximate="tanh")
def _silu(x):
    return torch.nn.functional.silu(x)
def _sigmoid(x):
    return torch.sigmoid(x)
def _layernorm(x, axis=-1, eps=1e-5):
    m = x.mean(dim=axis, keepdim=True)
    v = x.var(dim=axis, keepdim=True, unbiased=False)
    return (x - m) / torch.sqrt(v + eps)
def _scatter_add(tgt, idx, src, axis=0):
    return tgt.clone().index_add_(axis, idx, src)
def _segment_sum(src, seg, n):
    out = torch.zeros((n,) + src.shape[1:], dtype=src.dtype)
    return out.index_add_(0, seg, src)
def _pad(x, pw):
    flat = tuple(v for pair in reversed(pw) for v in pair)
    return torch.nn.functional.pad(x, flat)

kernel_name = 'standalone__mpnn_edge_mlp__graph'

def setup_inputs():

    _w = (lambda a: (lambda t: t.to(torch.bfloat16) if t.is_floating_point() else t)(torch.as_tensor(a)))
    N, deg, D, De = 10000, 16, 256, max(16, 1)
    E = N * deg
    return {
        "x": _w((lambda *s: torch.randn(*s, dtype=torch.bfloat16) * 0.05)(N, D)),
        "e_attr": _w((lambda *s: torch.randn(*s, dtype=torch.bfloat16) * 0.4)(E, De)),
        "src": _w((lambda lo, hi, *s: torch.randint(lo, hi, s))(0, N, E).to(torch.int64)),
        "dst": _w((lambda lo, hi, *s: torch.randint(lo, hi, s))(0, N, E).to(torch.int64)),
        "w_msg": _w((lambda *s: torch.randn(*s, dtype=torch.bfloat16) * 0.4)(2 * D + De, D)),
        "w_upd": _w((lambda *s: torch.randn(*s, dtype=torch.bfloat16) * 0.05)(2 * D, D)),
    }

def reference(x, e_attr, src, dst, w_msg, w_upd):
    N, D = x.shape
    m_in = torch.concatenate([x[src], x[dst], e_attr], axis=-1)
    msg = _silu(m_in @ w_msg)
    agg = _segment_sum(msg, dst, N)
    return _silu(torch.concatenate([x, agg], axis=-1) @ w_upd)
```

```asm
; @launch grid=(250,1,1) block=(512,1,1) lds=163840
.amdgcn_target "amdgcn-amd-amdhsa--gfx950"
.text
.globl standalone__mpnn_edge_mlp__graph_kernel
.p2align 8
.type standalone__mpnn_edge_mlp__graph_kernel,@function
standalone__mpnn_edge_mlp__graph_kernel:
    s_cmp_ge_u32 s2, 250
    s_cbranch_scc1 L_end
    s_load_dwordx16 s[4:19], s[0:1], 0
    s_load_dwordx2 s[20:21], s[0:1], 64
    s_getpc_b64 s[22:23]
    s_lshr_b32 s71, s2, 3
    s_lshl_b32 s71, s71, 4
    v_lshrrev_b32 v6, 5, v0
    v_add_u32 v6, s71, v6
    v_min_u32 v6, (L_end - standalone__mpnn_edge_mlp__graph_kernel) / 128 - 1, v6
    v_lshlrev_b32 v6, 7, v6
    v_mov_b32 v7, s23
    v_add_co_u32 v6, vcc, s22, v6
    s_mov_b32 exec_lo, 1
    s_mov_b32 exec_hi, 1
    v_addc_co_u32 v7, vcc, 0, v7, vcc
    global_load_dword v190, v[6:7], off
    s_mov_b64 exec, -1
    s_mov_b32 s82, s2
    s_and_b32 s71, s2, 7
    s_lshl_b32 s71, s71, 1
    s_bfe_u32 s72, s2, 0x10003
    s_or_b32 s71, s71, s72
    s_andn2_b32 s72, s2, 15
    s_or_b32 s71, s71, s72
    s_cmp_lt_u32 s2, 240
    s_cselect_b32 s2, s71, s2
    v_lshrrev_b32 v6, 6, v0
    v_and_b32 v7, 15, v0
    v_readfirstlane_b32 s68, v6
    v_bfe_u32 v134, v0, 4, 2
    v_lshlrev_b32 v1, 12, v134
    v_lshl_add_u32 v1, v6, 6, v1
    v_lshl_add_u32 v1, v7, 2, v1
    v_mul_u32_u24 v2, 544, v7
    v_lshl_add_u32 v2, v134, 4, v2
    v_lshl_add_u32 v3, v6, 6, v2
    v_add_u32 v2, 65536, v2
    v_lshrrev_b32 v6, 5, v0
    v_mul_u32_u24 v4, 544, v6
    v_and_b32 v6, 31, v0
    v_lshl_add_u32 v4, v6, 4, v4
    s_mul_i32 s71, s2, 20480
    v_lshl_add_u32 v5, v0, 4, s71
    s_mul_i32 s71, s2, 2560
    v_lshl_add_u32 v142, v0, 2, s71
    s_and_b32 s69, s68, 3
    s_lshr_b32 s70, s68, 2
    s_lshl_b32 s78, s69, 7
    s_lshl_b32 s79, s68, 12
    s_mov_b32 s76, 0x05040100
    s_mov_b32 s77, 0x07060302
    s_mov_b32 s84, 0x2b800000
    s_mov_b32 s85, 0x2b800000
    s_mov_b32 s86, 0xbfb8aa3b
    s_mov_b32 s87, 0xbfb8aa3b
    s_mov_b32 s81, 0
    s_waitcnt lgkmcnt(0)
    s_mov_b32 s36, s10
    s_and_b32 s37, s11, 0xffff
    s_mov_b32 s38, 640000
    s_mov_b32 s39, 0x20000
    s_mov_b32 s32, s8
    s_and_b32 s33, s9, 0xffff
    s_mov_b32 s34, 640000
    s_mov_b32 s35, 0x20000
    s_mov_b32 s24, s4
    s_and_b32 s25, s5, 0xffff
    s_mov_b32 s26, 5120000
    s_mov_b32 s27, 0x20000
    s_cmp_lt_u32 s68, 4
    s_cbranch_scc1 L_nods
    s_cmp_lt_u32 s68, 6
    s_cselect_b32 s71, 2048, s38
    v_subrev_u32 v142, 1024, v142
    buffer_load_dword v30, v142, s[36:39], 0 offen
    buffer_load_dword v31, v142, s[32:35], 0 offen
    buffer_load_dword v32, v142, s[36:39], 0 offen offset:1024
    buffer_load_dword v33, v142, s[32:35], 0 offen offset:1024
    buffer_load_dword v34, v142, s[36:39], s71 offen
    buffer_load_dword v35, v142, s[32:35], s71 offen
L_nods:
    s_and_b32 s71, s2, 1
    s_lshl_b32 s72, s71, 8
    s_mul_i32 s73, s70, 130816
    s_add_u32 s72, s72, s73
    s_add_u32 s42, s12, s72
    s_addc_u32 s43, s13, 0
    s_mul_i32 s71, s71, 40960
    s_sub_u32 s72, 24576, s71
    v_add_u32 v187, s72, v5
    s_sub_u32 s72, s72, 8192
    s_cmp_lt_u32 s68, 4
    s_cselect_b32 s72, 16384, s72
    v_add_u32 v186, s72, v5
    s_lshr_b32 s71, s82, 3
    s_mul_i32 s71, s71, 8
    s_add_u32 s71, s71, s68
    s_mul_i32 s71, s71, 9
    v_and_b32 v6, 63, v0
    v_add_u32 v6, s71, v6
    v_min_u32 v6, 2111, v6
    v_lshlrev_b32 v6, 7, v6
    s_add_u32 s22, s12, 0
    s_addc_u32 s23, s13, 0
    s_mov_b64 exec, 511
    global_load_dword v188, v6, s[22:23]
    s_mov_b64 exec, -1
    s_add_u32 s52, s20, 9437184
    s_addc_u32 s53, s21, 0
    s_and_b32 s53, s53, 0xffff
    s_mov_b32 s54, 32772
    s_mov_b32 s55, 0x20000
    v_mov_b32 v6, 0x8000
    buffer_load_dword v184, v6, s[52:55], 0 offen
    s_mov_b32 s75, 8192
    buffer_load_dwordx4 v[8:11], v5, s[24:27], 0 offen
    buffer_load_dwordx4 v[12:15], v5, s[24:27], s75 offen
    buffer_load_dwordx4 v[16:19], v186, s[24:27], 0 offen
    s_lshr_b32 s71, s82, 3
    s_mul_i32 s71, s71, 8
    s_add_u32 s71, s71, s68
    s_mul_i32 s71, s71, 9
    v_and_b32 v6, 63, v0
    v_add_u32 v6, s71, v6
    v_min_u32 v6, 2047, v6
    v_lshlrev_b32 v6, 7, v6
    s_add_u32 s22, s14, 0
    s_addc_u32 s23, s15, 0
    s_mov_b64 exec, 511
    global_load_dword v189, v6, s[22:23]
    s_mov_b64 exec, -1
    v_mov_b32 v138, -1
    v_mov_b32 v139, -1
    v_mov_b32 v140, -1
    v_mov_b32 v141, -1
    v_lshlrev_b32 v6, 4, v0
    ds_write_b128 v6, v[138:141] offset:0
    v_cmp_gt_u32 vcc, 488, v0
    s_and_saveexec_b64 s[88:89], vcc
    ds_write_b128 v6, v[138:141] offset:8192
    s_mov_b64 exec, -1
    v_mov_b32 v7, 0
    v_lshlrev_b32 v6, 1, v0
    ds_write_b16 v6, v7 offset:16000
    v_mov_b32 v134, 0
    v_mov_b32 v135, 0
    v_mov_b32 v136, 0
    v_mov_b32 v137, 0
    v_lshlrev_b32 v6, 4, v0
    v_add_u32 v6, 113920, v6
    ds_write_b128 v6, v[134:137] offset:0
    ds_write_b128 v6, v[134:137] offset:8192
    ds_write_b128 v6, v[134:137] offset:16384
    ds_write_b128 v6, v[134:137] offset:24576
    v_cmp_gt_u32 vcc, 449, v0
    s_and_saveexec_b64 s[88:89], vcc
    ds_write_b128 v6, v[134:137] offset:32768
    s_mov_b64 exec, -1
    v_cmp_gt_u32 vcc, 20, v0
    s_and_saveexec_b64 s[88:89], vcc
    ds_write_b128 v6, v[134:137] offset:47376
    s_mov_b64 exec, -1
    v_mov_b32 v138, 10000
    v_mov_b32 v139, 160000
    v_mov_b32 v140, 10000
    v_mov_b32 v141, 160000
    v_cmp_gt_u32 vcc, 464, v0
    s_and_saveexec_b64 s[88:89], vcc
    ds_write_b128 v6, v[138:141] offset:39952
    s_mov_b64 exec, -1
    s_mov_b32 s28, s6
    s_and_b32 s29, s7, 0xffff
    s_or_b32 s29, s29, 2097152
    s_mov_b32 s30, 160000
    s_mov_b32 s31, 0x20000
    s_mov_b32 s48, s16
    s_and_b32 s49, s17, 0xffff
    s_mov_b32 s50, 5120000
    s_mov_b32 s51, 0x20000
    s_mov_b32 s56, s20
    s_and_b32 s57, s21, 0xffff
    s_mov_b32 s58, 5120000
    s_mov_b32 s59, 0x20000
    s_mov_b32 s60, s20
    s_and_b32 s61, s21, 0xffff
    s_or_b32 s61, s61, 33554432
    s_mov_b32 s62, 10000
    s_mov_b32 s63, 0x20000
    s_add_u32 s64, s20, 5242880
    s_addc_u32 s65, s21, 0
    s_and_b32 s65, s65, 0xffff
    s_mov_b32 s66, 4000000
    s_mov_b32 s67, 0x20000
    s_add_u32 s44, s20, 10485760
    s_addc_u32 s45, s21, 0
    s_and_b32 s45, s45, 0xffff
    s_mov_b32 s46, 3328000
    s_mov_b32 s47, 0x20000
    buffer_load_dwordx4 v[20:23], v187, s[24:27], 0 offen
    buffer_load_dwordx4 v[24:27], v187, s[24:27], s75 offen
    s_waitcnt lgkmcnt(0)
    s_barrier
    s_cmp_gt_u32 s68, 3
    s_cbranch_scc1 L_qpath
    s_setprio 3
    s_add_u32 s90, s42, 0
    s_addc_u32 s91, s43, 0
    global_load_dword v40, v1, s[90:91] offset:0
    global_load_dword v44, v1, s[90:91] offset:512
    global_load_dword v41, v1, s[90:91] offset:1024
    global_load_dword v45, v1, s[90:91] offset:1536
    global_load_dword v42, v1, s[90:91] offset:2048
    global_load_dword v46, v1, s[90:91] offset:2560
    global_load_dword v43, v1, s[90:91] offset:3072
    global_load_dword v47, v1, s[90:91] offset:3584
    s_add_u32 s90, s42, 16384
    s_addc_u32 s91, s43, 0
    global_load_dword v48, v1, s[90:91] offset:0
    global_load_dword v52, v1, s[90:91] offset:512
    global_load_dword v49, v1, s[90:91] offset:1024
    global_load_dword v53, v1, s[90:91] offset:1536
    global_load_dword v50, v1, s[90:91] offset:2048
    global_load_dword v54, v1, s[90:91] offset:2560
    global_load_dword v51, v1, s[90:91] offset:3072
    global_load_dword v55, v1, s[90:91] offset:3584
    s_add_u32 s90, s42, 32768
    s_addc_u32 s91, s43, 0
    global_load_dword v56, v1, s[90:91] offset:0
    global_load_dword v60, v1, s[90:91] offset:512
    global_load_dword v57, v1, s[90:91] offset:1024
    global_load_dword v61, v1, s[90:91] offset:1536
    global_load_dword v58, v1, s[90:91] offset:2048
    global_load_dword v62, v1, s[90:91] offset:2560
    global_load_dword v59, v1, s[90:91] offset:3072
    global_load_dword v63, v1, s[90:91] offset:3584
    s_add_u32 s90, s42, 49152
    s_addc_u32 s91, s43, 0
    global_load_dword v64, v1, s[90:91] offset:0
    global_load_dword v68, v1, s[90:91] offset:512
    global_load_dword v65, v1, s[90:91] offset:1024
    global_load_dword v69, v1, s[90:91] offset:1536
    global_load_dword v66, v1, s[90:91] offset:2048
    global_load_dword v70, v1, s[90:91] offset:2560
    global_load_dword v67, v1, s[90:91] offset:3072
    global_load_dword v71, v1, s[90:91] offset:3584
    s_add_u32 s90, s42, 65536
    s_addc_u32 s91, s43, 0
    global_load_dword v72, v1, s[90:91] offset:0
    global_load_dword v76, v1, s[90:91] offset:512
    global_load_dword v73, v1, s[90:91] offset:1024
    global_load_dword v77, v1, s[90:91] offset:1536
    global_load_dword v74, v1, s[90:91] offset:2048
    global_load_dword v78, v1, s[90:91] offset:2560
    global_load_dword v75, v1, s[90:91] offset:3072
    global_load_dword v79, v1, s[90:91] offset:3584
    s_add_u32 s90, s42, 81920
    s_addc_u32 s91, s43, 0
    global_load_dword v80, v1, s[90:91] offset:0
    global_load_dword v84, v1, s[90:91] offset:512
    global_load_dword v81, v1, s[90:91] offset:1024
    global_load_dword v85, v1, s[90:91] offset:1536
    global_load_dword v82, v1, s[90:91] offset:2048
    global_load_dword v86, v1, s[90:91] offset:2560
    global_load_dword v83, v1, s[90:91] offset:3072
    global_load_dword v87, v1, s[90:91] offset:3584
    s_waitcnt vmcnt(48)
    v_add_u32 v6, 65536, v4
    ds_write_b128 v6, v[8:11] offset:0
    ds_write_b128 v6, v[12:15] offset:8704
    ds_write_b128 v6, v[16:19] offset:17408
    ds_write_b128 v6, v[20:23] offset:26112
    ds_write_b128 v6, v[24:27] offset:34816
    v_readfirstlane_b32 s3, v184
    s_mul_i32 s3, s3, 0x9e3779b1
    s_add_u32 s3, s3, 0x7f4a7c15
    s_waitcnt lgkmcnt(0)
    s_barrier
    ds_read_b128 v[104:107], v2 offset:0
    ds_read_b128 v[108:111], v2 offset:8704
    ds_read_b128 v[112:115], v2 offset:17408
    ds_read_b128 v[116:119], v2 offset:26112
    ds_read_b128 v[120:123], v2 offset:34816
    s_waitcnt vmcnt(40)
    v_perm_b32 v36, v44, v40, s76
    v_perm_b32 v44, v44, v40, s77
    v_perm_b32 v37, v45, v41, s76
    v_perm_b32 v45, v45, v41, s77
    v_perm_b32 v38, v46, v42, s76
    v_perm_b32 v46, v46, v42, s77
    v_perm_b32 v39, v47, v43, s76
    v_perm_b32 v47, v47, v43, s77
    s_waitcnt lgkmcnt(0)
    v_mfma_f32_16x16x32_bf16 v[144:147], v[36:39], v[104:107], 0
    ds_read_b128 v[124:127], v2 offset:64
    s_add_u32 s90, s42, 98304
    s_addc_u32 s91, s43, 0
    global_load_dword v88, v1, s[90:91] offset:0
    global_load_dword v92, v1, s[90:91] offset:512
    global_load_dword v89, v1, s[90:91] offset:1024
    v_mfma_f32_16x16x32_bf16 v[152:155], v[36:39], v[108:111], 0
    ds_read_b128 v[128:131], v2 offset:8768
    global_load_dword v93, v1, s[90:91] offset:1536
    global_load_dword v90, v1, s[90:91] offset:2048
    global_load_dword v94, v1, s[90:91] offset:2560
    v_mfma_f32_16x16x32_bf16 v[160:163], v[36:39], v[112:115], 0
    ds_read_b128 v[132:135], v2 offset:17472
    global_load_dword v91, v1, s[90:91] offset:3072
    global_load_dword v95, v1, s[90:91] offset:3584
    s_add_u32 s90, s42, 114688
    s_addc_u32 s91, s43, 0
    global_load_dword v96, v1, s[90:91] offset:0
    v_mfma_f32_16x16x32_bf16 v[168:171], v[36:39], v[116:119], 0
    ds_read_b128 v[136:139], v2 offset:26176
    global_load_dword v100, v1, s[90:91] offset:512
    global_load_dword v97, v1, s[90:91] offset:1024
    global_load_dword v101, v1, s[90:91] offset:1536
    v_mfma_f32_16x16x32_bf16 v[176:179], v[36:39], v[120:123], 0
    ds_read_b128 v[140:143], v2 offset:34880
    global_load_dword v98, v1, s[90:91] offset:2048
    global_load_dword v102, v1, s[90:91] offset:2560
    global_load_dword v99, v1, s[90:91] offset:3072
    v_mfma_f32_16x16x32_bf16 v[148:151], v[44:47], v[104:107], 0
    s_waitcnt vmcnt(47)
    v_perm_b32 v40, v52, v48, s76
    v_perm_b32 v52, v52, v48, s77
    v_mfma_f32_16x16x32_bf16 v[156:159], v[44:47], v[108:111], 0
    v_perm_b32 v41, v53, v49, s76
    v_perm_b32 v53, v53, v49, s77
    v_mfma_f32_16x16x32_bf16 v[164:167], v[44:47], v[112:115], 0
    v_perm_b32 v42, v54, v50, s76
    v_perm_b32 v54, v54, v50, s77
    v_mfma_f32_16x16x32_bf16 v[172:175], v[44:47], v[116:119], 0
    v_perm_b32 v43, v55, v51, s76
    v_perm_b32 v55, v55, v51, s77
    v_mfma_f32_16x16x32_bf16 v[180:183], v[44:47], v[120:123], 0
    global_load_dword v103, v1, s[90:91] offset:3584
    v_lshlrev_b32 v24, 4, v0
    s_add_u32 s90, s12, 262144
    s_addc_u32 s91, s13, 0
    global_load_dwordx4 v[24:27], v24, s[90:91]
    s_waitcnt lgkmcnt(0)
    v_mfma_f32_16x16x32_bf16 v[144:147], v[40:43], v[124:127], v[144:147]
    ds_read_b128 v[104:107], v2 offset:128
    v_mfma_f32_16x16x32_bf16 v[152:155], v[40:43], v[128:131], v[152:155]
    ds_read_b128 v[108:111], v2 offset:8832
    v_mfma_f32_16x16x32_bf16 v[160:163], v[40:43], v[132:135], v[160:163]
    ds_read_b128 v[112:115], v2 offset:17536
    v_mfma_f32_16x16x32_bf16 v[168:171], v[40:43], v[136:139], v[168:171]
    ds_read_b128 v[116:119], v2 offset:26240
    v_mfma_f32_16x16x32_bf16 v[176:179], v[40:43], v[140:143], v[176:179]
    ds_read_b128 v[120:123], v2 offset:34944
    v_mfma_f32_16x16x32_bf16 v[148:151], v[52:55], v[124:127], v[148:151]
    s_waitcnt vmcnt(41)
    v_perm_b32 v48, v60, v56, s76
    v_perm_b32 v60, v60, v56, s77
    v_mfma_f32_16x16x32_bf16 v[156:159], v[52:55], v[128:131], v[156:159]
    v_perm_b32 v49, v61, v57, s76
    v_perm_b32 v61, v61, v57, s77
    v_mfma_f32_16x16x32_bf16 v[164:167], v[52:55], v[132:135], v[164:167]
    v_perm_b32 v50, v62, v58, s76
    v_perm_b32 v62, v62, v58, s77
    v_mfma_f32_16x16x32_bf16 v[172:175], v[52:55], v[136:139], v[172:175]
    v_perm_b32 v51, v63, v59, s76
    v_perm_b32 v63, v63, v59, s77
    v_mfma_f32_16x16x32_bf16 v[180:183], v[52:55], v[140:143], v[180:183]
    s_waitcnt lgkmcnt(0)
    v_mfma_f32_16x16x32_bf16 v[144:147], v[48:51], v[104:107], v[144:147]
    ds_read_b128 v[124:127], v2 offset:192
    v_mfma_f32_16x16x32_bf16 v[152:155], v[48:51], v[108:111], v[152:155]
    ds_read_b128 v[128:131], v2 offset:8896
    v_mfma_f32_16x16x32_bf16 v[160:163], v[48:51], v[112:115], v[160:163]
    ds_read_b128 v[132:135], v2 offset:17600
    v_mfma_f32_16x16x32_bf16 v[168:171], v[48:51], v[116:119], v[168:171]
    ds_read_b128 v[136:139], v2 offset:26304
    v_mfma_f32_16x16x32_bf16 v[176:179], v[48:51], v[120:123], v[176:179]
    ds_read_b128 v[140:143], v2 offset:35008
    v_mfma_f32_16x16x32_bf16 v[148:151], v[60:63], v[104:107], v[148:151]
    s_waitcnt vmcnt(33)
    v_perm_b32 v56, v68, v64, s76
    v_perm_b32 v68, v68, v64, s77
    v_mfma_f32_16x16x32_bf16 v[156:159], v[60:63], v[108:111], v[156:159]
    v_perm_b32 v57, v69, v65, s76
    v_perm_b32 v69, v69, v65, s77
    v_mfma_f32_16x16x32_bf16 v[164:167], v[60:63], v[112:115], v[164:167]
    v_perm_b32 v58, v70, v66, s76
    v_perm_b32 v70, v70, v66, s77
    v_mfma_f32_16x16x32_bf16 v[172:175], v[60:63], v[116:119], v[172:175]
    v_perm_b32 v59, v71, v67, s76
    v_perm_b32 v71, v71, v67, s77
    v_mfma_f32_16x16x32_bf16 v[180:183], v[60:63], v[120:123], v[180:183]
    s_waitcnt lgkmcnt(0)
    v_mfma_f32_16x16x32_bf16 v[144:147], v[56:59], v[124:127], v[144:147]
    ds_read_b128 v[104:107], v2 offset:256
    v_mfma_f32_16x16x32_bf16 v[152:155], v[56:59], v[128:131], v[152:155]
    ds_read_b128 v[108:111], v2 offset:8960
    v_mfma_f32_16x16x32_bf16 v[160:163], v[56:59], v[132:135], v[160:163]
    ds_read_b128 v[112:115], v2 offset:17664
    v_mfma_f32_16x16x32_bf16 v[168:171], v[56:59], v[136:139], v[168:171]
    ds_read_b128 v[116:119], v2 offset:26368
    v_mfma_f32_16x16x32_bf16 v[176:179], v[56:59], v[140:143], v[176:179]
    ds_read_b128 v[120:123], v2 offset:35072
    v_mfma_f32_16x16x32_bf16 v[148:151], v[68:71], v[124:127], v[148:151]
    s_waitcnt vmcnt(25)
    v_perm_b32 v64, v76, v72, s76
    v_perm_b32 v76, v76, v72, s77
    v_mfma_f32_16x16x32_bf16 v[156:159], v[68:71], v[128:131], v[156:159]
    v_perm_b32 v65, v77, v73, s76
    v_perm_b32 v77, v77, v73, s77
    v_mfma_f32_16x16x32_bf16 v[164:167], v[68:71], v[132:135], v[164:167]
    v_perm_b32 v66, v78, v74, s76
    v_perm_b32 v78, v78, v74, s77
    v_mfma_f32_16x16x32_bf16 v[172:175], v[68:71], v[136:139], v[172:175]
    v_perm_b32 v67, v79, v75, s76
    v_perm_b32 v79, v79, v75, s77
    v_mfma_f32_16x16x32_bf16 v[180:183], v[68:71], v[140:143], v[180:183]
    s_waitcnt lgkmcnt(0)
    v_mfma_f32_16x16x32_bf16 v[144:147], v[64:67], v[104:107], v[144:147]
    ds_read_b128 v[124:127], v2 offset:320
    v_mfma_f32_16x16x32_bf16 v[152:155], v[64:67], v[108:111], v[152:155]
    ds_read_b128 v[128:131], v2 offset:9024
    v_mfma_f32_16x16x32_bf16 v[160:163], v[64:67], v[112:115], v[160:163]
    ds_read_b128 v[132:135], v2 offset:17728
    v_mfma_f32_16x16x32_bf16 v[168:171], v[64:67], v[116:119], v[168:171]
    ds_read_b128 v[136:139], v2 offset:26432
    v_mfma_f32_16x16x32_bf16 v[176:179], v[64:67], v[120:123], v[176:179]
    ds_read_b128 v[140:143], v2 offset:35136
    v_mfma_f32_16x16x32_bf16 v[148:151], v[76:79], v[104:107], v[148:151]
    s_waitcnt vmcnt(17)
    v_perm_b32 v72, v84, v80, s76
    v_perm_b32 v84, v84, v80, s77
    v_mfma_f32_16x16x32_bf16 v[156:159], v[76:79], v[108:111], v[156:159]
    v_perm_b32 v73, v85, v81, s76
    v_perm_b32 v85, v85, v81, s77
    v_mfma_f32_16x16x32_bf16 v[164:167], v[76:79], v[112:115], v[164:167]
    v_perm_b32 v74, v86, v82, s76
    v_perm_b32 v86, v86, v82, s77
    v_mfma_f32_16x16x32_bf16 v[172:175], v[76:79], v[116:119], v[172:175]
    v_perm_b32 v75, v87, v83, s76
    v_perm_b32 v87, v87, v83, s77
    v_mfma_f32_16x16x32_bf16 v[180:183], v[76:79], v[120:123], v[180:183]
    s_waitcnt lgkmcnt(0)
    v_mfma_f32_16x16x32_bf16 v[144:147], v[72:75], v[124:127], v[144:147]
    ds_read_b128 v[104:107], v2 offset:384
    v_mfma_f32_16x16x32_bf16 v[152:155], v[72:75], v[128:131], v[152:155]
    ds_read_b128 v[108:111], v2 offset:9088
    v_mfma_f32_16x16x32_bf16 v[160:163], v[72:75], v[132:135], v[160:163]
    ds_read_b128 v[112:115], v2 offset:17792
    v_mfma_f32_16x16x32_bf16 v[168:171], v[72:75], v[136:139], v[168:171]
    ds_read_b128 v[116:119], v2 offset:26496
    v_mfma_f32_16x16x32_bf16 v[176:179], v[72:75], v[140:143], v[176:179]
    ds_read_b128 v[120:123], v2 offset:35200
    v_mfma_f32_16x16x32_bf16 v[148:151], v[84:87], v[124:127], v[148:151]
    s_waitcnt vmcnt(9)
    v_perm_b32 v80, v92, v88, s76
    v_perm_b32 v92, v92, v88, s77
    v_mfma_f32_16x16x32_bf16 v[156:159], v[84:87], v[128:131], v[156:159]
    v_perm_b32 v81, v93, v89, s76
    v_perm_b32 v93, v93, v89, s77
    v_mfma_f32_16x16x32_bf16 v[164:167], v[84:87], v[132:135], v[164:167]
    v_perm_b32 v82, v94, v90, s76
    v_perm_b32 v94, v94, v90, s77
    v_mfma_f32_16x16x32_bf16 v[172:175], v[84:87], v[136:139], v[172:175]
    v_perm_b32 v83, v95, v91, s76
    v_perm_b32 v95, v95, v91, s77
    v_mfma_f32_16x16x32_bf16 v[180:183], v[84:87], v[140:143], v[180:183]
    s_waitcnt lgkmcnt(0)
    v_mfma_f32_16x16x32_bf16 v[144:147], v[80:83], v[104:107], v[144:147]
    ds_read_b128 v[124:127], v2 offset:448
    v_mfma_f32_16x16x32_bf16 v[152:155], v[80:83], v[108:111], v[152:155]
    ds_read_b128 v[128:131], v2 offset:9152
    v_mfma_f32_16x16x32_bf16 v[160:163], v[80:83], v[112:115], v[160:163]
    ds_read_b128 v[132:135], v2 offset:17856
    v_mfma_f32_16x16x32_bf16 v[168:171], v[80:83], v[116:119], v[168:171]
    ds_read_b128 v[136:139], v2 offset:26560
    v_mfma_f32_16x16x32_bf16 v[176:179], v[80:83], v[120:123], v[176:179]
    ds_read_b128 v[140:143], v2 offset:35264
    v_mfma_f32_16x16x32_bf16 v[148:151], v[92:95], v[104:107], v[148:151]
    s_waitcnt vmcnt(1)
    v_perm_b32 v88, v100, v96, s76
    v_perm_b32 v100, v100, v96, s77
    v_mfma_f32_16x16x32_bf16 v[156:159], v[92:95], v[108:111], v[156:159]
    v_perm_b32 v89, v101, v97, s76
    v_perm_b32 v101, v101, v97, s77
    v_mfma_f32_16x16x32_bf16 v[164:167], v[92:95], v[112:115], v[164:167]
    v_perm_b32 v90, v102, v98, s76
    v_perm_b32 v102, v102, v98, s77
    v_mfma_f32_16x16x32_bf16 v[172:175], v[92:95], v[116:119], v[172:175]
    v_perm_b32 v91, v103, v99, s76
    v_perm_b32 v103, v103, v99, s77
    v_mfma_f32_16x16x32_bf16 v[180:183], v[92:95], v[120:123], v[180:183]
    s_lshl_b32 s74, s68, 8
    s_add_u32 s74, s74, s2
    s_cmp_ge_u32 s74, 64
    s_cbranch_scc1 L_notw
    s_lshr_b32 s71, s2, 3
    s_lshl_b32 s71, s71, 6
    s_and_b32 s72, s2, 7
    s_lshl_b32 s72, s72, 14
    s_add_u32 s71, s71, s72
    s_add_u32 s22, s14, s71
    s_addc_u32 s23, s15, 0
    s_add_u32 s90, s22, 131072
    s_addc_u32 s91, s23, 0
    global_load_dword v192, v1, s[90:91] offset:0
    global_load_dword v196, v1, s[90:91] offset:512
    global_load_dword v193, v1, s[90:91] offset:1024
    global_load_dword v197, v1, s[90:91] offset:1536
    global_load_dword v194, v1, s[90:91] offset:2048
    global_load_dword v198, v1, s[90:91] offset:2560
    global_load_dword v195, v1, s[90:91] offset:3072
    global_load_dword v199, v1, s[90:91] offset:3584
L_notw:
    s_waitcnt lgkmcnt(0)
    v_mfma_f32_16x16x32_bf16 v[144:147], v[88:91], v[124:127], v[144:147]
    v_mfma_f32_16x16x32_bf16 v[152:155], v[88:91], v[128:131], v[152:155]
    v_mfma_f32_16x16x32_bf16 v[160:163], v[88:91], v[132:135], v[160:163]
    v_mfma_f32_16x16x32_bf16 v[168:171], v[88:91], v[136:139], v[168:171]
    v_mfma_f32_16x16x32_bf16 v[176:179], v[88:91], v[140:143], v[176:179]
    v_mfma_f32_16x16x32_bf16 v[148:151], v[100:103], v[124:127], v[148:151]
    v_mfma_f32_16x16x32_bf16 v[156:159], v[100:103], v[128:131], v[156:159]
    v_mfma_f32_16x16x32_bf16 v[164:167], v[100:103], v[132:135], v[164:167]
    v_mfma_f32_16x16x32_bf16 v[172:175], v[100:103], v[136:139], v[172:175]
    v_mfma_f32_16x16x32_bf16 v[180:183], v[100:103], v[140:143], v[180:183]
    s_nop 7
    v_pk_mul_f32 v[144:145], v[144:145], s[86:87]
    v_pk_mul_f32 v[146:147], v[146:147], s[86:87]
    v_pk_mul_f32 v[148:149], v[148:149], s[86:87]
    v_pk_mul_f32 v[150:151], v[150:151], s[86:87]
    v_cvt_pk_bf16_f32 v144, v144, v148
    v_cvt_pk_bf16_f32 v145, v145, v149
    v_cvt_pk_bf16_f32 v146, v146, v150
    v_cvt_pk_bf16_f32 v147, v147, v151
    ds_write_b128 v3, v[144:147] offset:17408
    v_pk_mul_f32 v[152:153], v[152:153], s[86:87]
    v_pk_mul_f32 v[154:155], v[154:155], s[86:87]
    v_pk_mul_f32 v[156:157], v[156:157], s[86:87]
    v_pk_mul_f32 v[158:159], v[158:159], s[86:87]
    v_cvt_pk_bf16_f32 v152, v152, v156
    v_cvt_pk_bf16_f32 v153, v153, v157
    v_cvt_pk_bf16_f32 v154, v154, v158
    v_cvt_pk_bf16_f32 v155, v155, v159
    ds_write_b128 v3, v[152:155] offset:26112
    v_pk_mul_f32 v[160:161], v[160:161], s[86:87]
    v_pk_mul_f32 v[162:163], v[162:163], s[86:87]
    v_pk_mul_f32 v[164:165], v[164:165], s[86:87]
    v_pk_mul_f32 v[166:167], v[166:167], s[86:87]
    v_cvt_pk_bf16_f32 v160, v160, v164
    v_cvt_pk_bf16_f32 v161, v161, v165
    v_cvt_pk_bf16_f32 v162, v162, v166
    v_cvt_pk_bf16_f32 v163, v163, v167
    ds_write_b128 v3, v[160:163] offset:34816
    v_pk_mul_f32 v[168:169], v[168:169], s[86:87]
    v_pk_mul_f32 v[170:171], v[170:171], s[86:87]
    v_pk_mul_f32 v[172:173], v[172:173], s[86:87]
    v_pk_mul_f32 v[174:175], v[174:175], s[86:87]
    v_cvt_pk_bf16_f32 v168, v168, v172
    v_cvt_pk_bf16_f32 v169, v169, v173
    v_cvt_pk_bf16_f32 v170, v170, v174
    v_cvt_pk_bf16_f32 v171, v171, v175
    ds_write_b128 v3, v[168:171] offset:43520
    v_pk_mul_f32 v[176:177], v[176:177], s[86:87]
    v_pk_mul_f32 v[178:179], v[178:179], s[86:87]
    v_pk_mul_f32 v[180:181], v[180:181], s[86:87]
    v_pk_mul_f32 v[182:183], v[182:183], s[86:87]
    v_cvt_pk_bf16_f32 v176, v176, v180
    v_cvt_pk_bf16_f32 v177, v177, v181
    v_cvt_pk_bf16_f32 v178, v178, v182
    v_cvt_pk_bf16_f32 v179, v179, v183
    ds_write_b128 v3, v[176:179] offset:52224
    v_bfe_u32 v6, v0, 2, 4
    v_and_b32 v7, 3, v0
    v_lshlrev_b32 v7, 4, v7
    v_lshl_add_u32 v7, s68, 6, v7
    v_lshl_add_u32 v184, v6, 9, v7
    v_mul_u32_u24 v6, 544, v6
    v_add_u32 v6, v6, v7
    s_waitcnt lgkmcnt(0)
    ds_read_b128 v[40:43], v6 offset:17408
    ds_read_b128 v[44:47], v6 offset:26112
    ds_read_b128 v[48:51], v6 offset:34816
    ds_read_b128 v[52:55], v6 offset:43520
    ds_read_b128 v[56:59], v6 offset:52224
    s_and_b32 s71, s2, 1
    s_mul_i32 s72, s2, 20480
    s_lshl_b32 s73, s71, 8
    s_add_u32 s72, s72, s73
    v_add_u32 v184, s72, v184
    s_mul_i32 s71, s71, 40960
    s_sub_u32 s72, 24576, s71
    v_add_u32 v187, s72, v184
    v_add_u32 v186, 16384, v184
    s_mov_b32 exec_lo, 0
    v_subrev_u32 v186, s71, v186
    s_mov_b32 exec_lo, -1
    s_waitcnt lgkmcnt(4)
    buffer_store_dwordx4 v[40:43], v184, s[56:59], 0 offen sc1
    s_waitcnt lgkmcnt(3)
    buffer_store_dwordx4 v[44:47], v184, s[56:59], s75 offen sc1
    s_waitcnt lgkmcnt(2)
    buffer_store_dwordx4 v[48:51], v186, s[56:59], 0 offen sc1
    s_waitcnt lgkmcnt(1)
    buffer_store_dwordx4 v[52:55], v187, s[56:59], 0 offen sc1
    s_waitcnt lgkmcnt(0)
    buffer_store_dwordx4 v[56:59], v187, s[56:59], s75 offen sc1
    s_cmp_ge_u32 s74, 64
    s_cbranch_scc1 L_notw2
    s_lshl_b32 s71, s2, 11
    s_add_u32 s71, s71, 14680064
    s_add_u32 s90, s20, s71
    s_addc_u32 s91, s21, 0
    v_lshlrev_b32 v6, 4, v0
    s_waitcnt vmcnt(5)
    v_perm_b32 v188, v196, v192, s76
    v_perm_b32 v196, v196, v192, s77
    v_perm_b32 v189, v197, v193, s76
    v_perm_b32 v197, v197, v193, s77
    v_perm_b32 v190, v198, v194, s76
    v_perm_b32 v198, v198, v194, s77
    v_perm_b32 v191, v199, v195, s76
    v_perm_b32 v199, v199, v195, s77
    global_store_dwordx4 v6, v[188:191], s[90:91] sc1
    global_store_dwordx4 v6, v[196:199], s[90:91] offset:1024 sc1
L_notw2:
    s_setprio 0
    v_lshrrev_b32 v7, 1, v0
    v_min_u32 v7, 249, v7
    v_and_b32 v6, 1, v0
    v_lshlrev_b32 v6, 4, v6
    v_lshl_add_u32 v28, v7, 6, v6
    s_mul_i32 s80, s2, 16000
    buffer_load_dwordx4 v[8:11], v28, s[64:67], s80 offen offset:0 sc1
    buffer_load_dwordx4 v[12:15], v28, s[64:67], s80 offen offset:32 sc1
    s_waitcnt vmcnt(7)
    v_lshlrev_b32 v16, 16, v24
    v_and_b32 v17, 0xffff0000, v24
    v_lshlrev_b32 v18, 16, v25
    v_and_b32 v19, 0xffff0000, v25
    v_lshlrev_b32 v20, 16, v26
    v_and_b32 v21, 0xffff0000, v26
    v_lshlrev_b32 v22, 16, v27
    v_and_b32 v23, 0xffff0000, v27
    v_pk_mul_f32 v[16:17], v[16:17], s[86:87]
    v_pk_mul_f32 v[18:19], v[18:19], s[86:87]
    v_pk_mul_f32 v[20:21], v[20:21], s[86:87]
    v_pk_mul_f32 v[22:23], v[22:23], s[86:87]
    v_cvt_pk_bf16_f32 v24, v16, v17
    v_cvt_pk_bf16_f32 v25, v18, v19
    v_cvt_pk_bf16_f32 v26, v20, v21
    v_cvt_pk_bf16_f32 v27, v22, v23
    s_mul_i32 s72, s70, 43776
    v_add_u32 v16, s72, v4
    ds_write_b128 v16, v[24:27] offset:60928
    v_bfe_u32 v134, v0, 5, 1
    v_bfe_u32 v135, v0, 4, 1
    v_bfe_u32 v136, v0, 2, 2
    v_and_b32 v137, 3, v0
    v_lshlrev_b32 v138, 3, v137
    v_lshl_add_u32 v138, v135, 5, v138
    v_lshl_add_u32 v139, v134, 3, v136
    s_lshr_b32 s41, s69, 1
    s_xor_b32 s41, s41, s2
    s_and_b32 s41, s41, 1
    s_lshl_b32 s71, s41, 1
    s_add_u32 s71, s71, s70
    s_mul_i32 s71, s71, 10880
    s_and_b32 s72, s78, 128
    s_add_u32 s71, s71, s72
    v_mul_u32_u24 v6, 544, v139
    v_mul_u32_u24 v7, 544, v136
    v_mul_u32_u24 v141, 48128, v134
    v_add3_u32 v141, v141, v138, s78
    v_add_u32 v141, v141, v7
    v_add3_u32 v6, v6, v138, s71
    v_add3_u32 v7, v7, v138, s71
    s_lshl_b32 s71, s2, 4
    s_add_u32 s71, s71, s68
    s_lshl_b32 s71, s71, 2
    v_mov_b32 v142, s71
    v_mov_b32 v143, s3
    s_waitcnt vmcnt(2)
    s_mov_b64 exec, 1
    buffer_store_dword v143, v142, s[52:55], 0 offen sc1
    s_mov_b64 exec, -1
    s_add_u32 s90, s14, 0
    s_addc_u32 s91, s15, 0
    global_load_dword v192, v1, s[90:91] offset:0
    global_load_dword v196, v1, s[90:91] offset:512
    global_load_dword v193, v1, s[90:91] offset:1024
    global_load_dword v197, v1, s[90:91] offset:1536
    global_load_dword v194, v1, s[90:91] offset:2048
    global_load_dword v198, v1, s[90:91] offset:2560
    global_load_dword v195, v1, s[90:91] offset:3072
    global_load_dword v199, v1, s[90:91] offset:3584
    s_add_u32 s90, s14, 16384
    s_addc_u32 s91, s15, 0
    global_load_dword v200, v1, s[90:91] offset:0
    global_load_dword v204, v1, s[90:91] offset:512
    global_load_dword v201, v1, s[90:91] offset:1024
    global_load_dword v205, v1, s[90:91] offset:1536
    global_load_dword v202, v1, s[90:91] offset:2048
    global_load_dword v206, v1, s[90:91] offset:2560
    global_load_dword v203, v1, s[90:91] offset:3072
    global_load_dword v207, v1, s[90:91] offset:3584
    s_add_u32 s90, s14, 32768
    s_addc_u32 s91, s15, 0
    global_load_dword v208, v1, s[90:91] offset:0
    global_load_dword v212, v1, s[90:91] offset:512
    global_load_dword v209, v1, s[90:91] offset:1024
    global_load_dword v213, v1, s[90:91] offset:1536
    global_load_dword v210, v1, s[90:91] offset:2048
    global_load_dword v214, v1, s[90:91] offset:2560
    global_load_dword v211, v1, s[90:91] offset:3072
    global_load_dword v215, v1, s[90:91] offset:3584
    s_waitcnt vmcnt(25)
    s_waitcnt vmcnt(40) lgkmcnt(0)
    s_branch L_merge
L_qpath:
    s_waitcnt vmcnt(8)
    v_mul_u32_u24 v134, 52429, v30
    v_lshrrev_b32 v134, 21, v134
    v_mul_u32_u24 v135, 40, v134
    v_sub_u32 v135, v30, v135
    v_lshlrev_b32 v136, 2, v134
    v_mov_b32 v137, 1
    ds_add_rtn_u32 v136, v136, v137 offset:16000
    v_cmp_lt_u32 vcc, 19, v135
    v_add_u32 v137, 12, v135
    v_add_u32 v138, -256, v0
    v_cndmask_b32 v135, v135, v137, vcc
    v_lshl_or_b32 v31, v135, 14, v31
    v_lshl_or_b32 v31, v138, 20, v31
    v_bfrev_b32 v137, 1
    s_waitcnt lgkmcnt(0)
    v_cmp_lt_u32 vcc, 14, v136
    v_min_u32 v136, 15, v136
    v_lshl_add_u32 v136, v134, 4, v136
    v_cndmask_b32 v31, v31, v137, vcc
    v_lshlrev_b32 v136, 2, v136
    ds_write_b32 v136, v31 offset:0
    v_mul_u32_u24 v134, 52429, v32
    v_lshrrev_b32 v134, 21, v134
    v_mul_u32_u24 v135, 40, v134
    v_sub_u32 v135, v32, v135
    v_lshlrev_b32 v136, 2, v134
    v_mov_b32 v137, 1
    ds_add_rtn_u32 v136, v136, v137 offset:16000
    v_cmp_lt_u32 vcc, 19, v135
    v_add_u32 v137, 12, v135
    v_add_u32 v138, 0, v0
    v_cndmask_b32 v135, v135, v137, vcc
    v_lshl_or_b32 v33, v135, 14, v33
    v_lshl_or_b32 v33, v138, 20, v33
    v_bfrev_b32 v137, 1
    s_waitcnt lgkmcnt(0)
    v_cmp_lt_u32 vcc, 14, v136
    v_min_u32 v136, 15, v136
    v_lshl_add_u32 v136, v134, 4, v136
    v_cndmask_b32 v33, v33, v137, vcc
    v_lshlrev_b32 v136, 2, v136
    ds_write_b32 v136, v33 offset:0
    s_cmp_gt_u32 s68, 5
    s_cbranch_scc1 L_bin2
    v_mul_u32_u24 v134, 52429, v34
    v_lshrrev_b32 v134, 21, v134
    v_mul_u32_u24 v135, 40, v134
    v_sub_u32 v135, v34, v135
    v_lshlrev_b32 v136, 2, v134
    v_mov_b32 v137, 1
    ds_add_rtn_u32 v136, v136, v137 offset:16000
    v_cmp_lt_u32 vcc, 19, v135
    v_add_u32 v137, 12, v135
    v_add_u32 v138, 256, v0
    v_cndmask_b32 v135, v135, v137, vcc
    v_lshl_or_b32 v35, v135, 14, v35
    v_lshl_or_b32 v35, v138, 20, v35
    v_bfrev_b32 v137, 1
    s_waitcnt lgkmcnt(0)
    v_cmp_lt_u32 vcc, 14, v136
    v_min_u32 v136, 15, v136
    v_lshl_add_u32 v136, v134, 4, v136
    v_cndmask_b32 v35, v35, v137, vcc
    v_lshlrev_b32 v136, 2, v136
    ds_write_b32 v136, v35 offset:0
L_bin2:
    v_mov_b32 v6, 17000
    v_mov_b32 v7, 1
    s_waitcnt lgkmcnt(0)
    s_mov_b64 exec, 1
    ds_add_u32 v6, v7
    s_mov_b64 exec, -1
    s_waitcnt vmcnt(6)
    v_readfirstlane_b32 s3, v184
    v_mov_b32 v6, 17000
    s_mul_i32 s3, s3, 0x9e3779b1
    s_add_u32 s3, s3, 0x7f4a7c15
L_meet:
    ds_read_b32 v7, v6
    s_waitcnt lgkmcnt(0)
    v_readfirstlane_b32 s71, v7
    s_cmp_lt_u32 s71, 4
    s_cbranch_scc1 L_meet
    v_and_b32 v7, 255, v0
    v_lshlrev_b32 v6, 4, v7
    ds_read_b128 v[144:147], v6 offset:0
    ds_read_b128 v[148:151], v6 offset:4096
    ds_read_b128 v[152:155], v6 offset:8192
    ds_read_b128 v[156:159], v6 offset:12288
    v_lshrrev_b32 v6, 2, v7
    v_mul_u32_u24 v6, 16000, v6
    v_and_b32 v7, 3, v0
    v_lshl_add_u32 v6, v7, 4, v6
    s_lshl_b32 s71, s2, 6
    s_mov_b32 s88, 0x88888888
    s_mov_b32 s89, 0x88888888
    s_waitcnt lgkmcnt(0)
    s_mov_b64 exec, s[88:89]
    v_cmp_ne_u32 vcc, -1, v147
    s_nop 1
    v_cndmask_b32 v146, v146, v147, vcc
    v_mov_b32 v147, s3
    v_cmp_ne_u32 vcc, -1, v151
    s_nop 1
    v_cndmask_b32 v150, v150, v151, vcc
    v_mov_b32 v151, s3
    v_cmp_ne_u32 vcc, -1, v155
    s_nop 1
    v_cndmask_b32 v154, v154, v155, vcc
    v_mov_b32 v155, s3
    v_cmp_ne_u32 vcc, -1, v159
    s_nop 1
    v_cndmask_b32 v158, v158, v159, vcc
    v_mov_b32 v159, s3
    s_mov_b64 exec, -1
    v_xor_b32 v134, v144, v145
    v_bitop3_b32 v134, v134, v146, v147 bitop3:0x96
    v_xor_b32 v135, v148, v149
    v_bitop3_b32 v135, v135, v150, v151 bitop3:0x96
    v_xor_b32 v136, v152, v153
    v_bitop3_b32 v136, v136, v154, v155 bitop3:0x96
    v_xor_b32 v137, v156, v157
    v_bitop3_b32 v137, v137, v158, v159 bitop3:0x96
    v_xor_b32_dpp v134, v134, v134 quad_perm:[1,0,3,2] row_mask:0xf bank_mask:0xf
    v_xor_b32_dpp v135, v135, v135 quad_perm:[1,0,3,2] row_mask:0xf bank_mask:0xf
    v_xor_b32_dpp v136, v136, v136 quad_perm:[1,0,3,2] row_mask:0xf bank_mask:0xf
    v_xor_b32_dpp v137, v137, v137 quad_perm:[1,0,3,2] row_mask:0xf bank_mask:0xf
    v_xor_b32_dpp v134, v134, v134 quad_perm:[2,3,0,1] row_mask:0xf bank_mask:0xf
    v_xor_b32_dpp v135, v135, v135 quad_perm:[2,3,0,1] row_mask:0xf bank_mask:0xf
    v_xor_b32_dpp v136, v136, v136 quad_perm:[2,3,0,1] row_mask:0xf bank_mask:0xf
    v_xor_b32_dpp v137, v137, v137 quad_perm:[2,3,0,1] row_mask:0xf bank_mask:0xf
    v_lshl_add_u32 v7, v7, 1, 3
    v_mul_lo_u32 v7, v7, s3
    v_xor_b32 v144, v144, v7
    v_xor_b32 v148, v148, v7
    v_xor_b32 v152, v152, v7
    v_xor_b32 v156, v156, v7
    v_cndmask_b32 v147, v147, v134, s[88:89]
    buffer_store_dwordx4 v[144:147], v6, s[64:67], s71 offen sc1
    s_add_u32 s71, s71, 1024000
    v_cndmask_b32 v151, v151, v135, s[88:89]
    buffer_store_dwordx4 v[148:151], v6, s[64:67], s71 offen sc1
    s_add_u32 s71, s71, 1024000
    v_cndmask_b32 v155, v155, v136, s[88:89]
    buffer_store_dwordx4 v[152:155], v6, s[64:67], s71 offen sc1
    s_add_u32 s71, s71, 1024000
    v_cndmask_b32 v159, v159, v137, s[88:89]
    buffer_store_dwordx4 v[156:159], v6, s[64:67], s71 offen sc1
    s_add_u32 s71, s71, 1024000
    s_waitcnt vmcnt(4)
    v_add_u32 v6, 65536, v4
    ds_write_b128 v6, v[8:11] offset:0
    ds_write_b128 v6, v[12:15] offset:8704
    ds_write_b128 v6, v[16:19] offset:17408
    ds_write_b128 v6, v[20:23] offset:26112
    ds_write_b128 v6, v[24:27] offset:34816
    v_readfirstlane_b32 s3, v184
    s_mul_i32 s3, s3, 0x9e3779b1
    s_add_u32 s3, s3, 0x7f4a7c15
    s_waitcnt lgkmcnt(0)
    s_barrier
    v_lshrrev_b32 v7, 1, v0
    v_min_u32 v7, 249, v7
    v_and_b32 v6, 1, v0
    v_lshlrev_b32 v6, 4, v6
    v_lshl_add_u32 v28, v7, 6, v6
    s_mul_i32 s80, s2, 16000
    s_add_u32 s90, s42, 0
    s_addc_u32 s91, s43, 0
    global_load_dword v40, v1, s[90:91] offset:0
    global_load_dword v44, v1, s[90:91] offset:512
    global_load_dword v41, v1, s[90:91] offset:1024
    global_load_dword v45, v1, s[90:91] offset:1536
    global_load_dword v42, v1, s[90:91] offset:2048
    global_load_dword v46, v1, s[90:91] offset:2560
    global_load_dword v43, v1, s[90:91] offset:3072
    global_load_dword v47, v1, s[90:91] offset:3584
    s_add_u32 s90, s42, 16384
    s_addc_u32 s91, s43, 0
    global_load_dword v48, v1, s[90:91] offset:0
    global_load_dword v52, v1, s[90:91] offset:512
    global_load_dword v49, v1, s[90:91] offset:1024
    global_load_dword v53, v1, s[90:91] offset:1536
    global_load_dword v50, v1, s[90:91] offset:2048
    global_load_dword v54, v1, s[90:91] offset:2560
    global_load_dword v51, v1, s[90:91] offset:3072
    global_load_dword v55, v1, s[90:91] offset:3584
    s_add_u32 s90, s42, 32768
    s_addc_u32 s91, s43, 0
    global_load_dword v56, v1, s[90:91] offset:0
    global_load_dword v60, v1, s[90:91] offset:512
    global_load_dword v57, v1, s[90:91] offset:1024
    global_load_dword v61, v1, s[90:91] offset:1536
    global_load_dword v58, v1, s[90:91] offset:2048
    global_load_dword v62, v1, s[90:91] offset:2560
    global_load_dword v59, v1, s[90:91] offset:3072
    global_load_dword v63, v1, s[90:91] offset:3584
    s_add_u32 s90, s42, 49152
    s_addc_u32 s91, s43, 0
    global_load_dword v64, v1, s[90:91] offset:0
    global_load_dword v68, v1, s[90:91] offset:512
    global_load_dword v65, v1, s[90:91] offset:1024
    global_load_dword v69, v1, s[90:91] offset:1536
    global_load_dword v66, v1, s[90:91] offset:2048
    global_load_dword v70, v1, s[90:91] offset:2560
    global_load_dword v67, v1, s[90:91] offset:3072
    global_load_dword v71, v1, s[90:91] offset:3584
    s_add_u32 s90, s42, 65536
    s_addc_u32 s91, s43, 0
    global_load_dword v72, v1, s[90:91] offset:0
    global_load_dword v76, v1, s[90:91] offset:512
    global_load_dword v73, v1, s[90:91] offset:1024
    global_load_dword v77, v1, s[90:91] offset:1536
    global_load_dword v74, v1, s[90:91] offset:2048
    global_load_dword v78, v1, s[90:91] offset:2560
    global_load_dword v75, v1, s[90:91] offset:3072
    global_load_dword v79, v1, s[90:91] offset:3584
    s_add_u32 s90, s42, 81920
    s_addc_u32 s91, s43, 0
    global_load_dword v80, v1, s[90:91] offset:0
    global_load_dword v84, v1, s[90:91] offset:512
    global_load_dword v81, v1, s[90:91] offset:1024
    global_load_dword v85, v1, s[90:91] offset:1536
    global_load_dword v82, v1, s[90:91] offset:2048
    global_load_dword v86, v1, s[90:91] offset:2560
    global_load_dword v83, v1, s[90:91] offset:3072
    global_load_dword v87, v1, s[90:91] offset:3584
    s_add_u32 s90, s42, 98304
    s_addc_u32 s91, s43, 0
    global_load_dword v88, v1, s[90:91] offset:0
    global_load_dword v92, v1, s[90:91] offset:512
    global_load_dword v89, v1, s[90:91] offset:1024
    global_load_dword v93, v1, s[90:91] offset:1536
    global_load_dword v90, v1, s[90:91] offset:2048
    global_load_dword v94, v1, s[90:91] offset:2560
    s_waitcnt vmcnt(50)
    global_load_dword v91, v1, s[90:91] offset:3072
    global_load_dword v95, v1, s[90:91] offset:3584
    s_add_u32 s90, s42, 114688
    s_addc_u32 s91, s43, 0
    global_load_dword v96, v1, s[90:91] offset:0
    global_load_dword v100, v1, s[90:91] offset:512
    global_load_dword v97, v1, s[90:91] offset:1024
    global_load_dword v101, v1, s[90:91] offset:1536
    global_load_dword v98, v1, s[90:91] offset:2048
    s_waitcnt vmcnt(50)
    global_load_dword v102, v1, s[90:91] offset:2560
    global_load_dword v99, v1, s[90:91] offset:3072
    global_load_dword v103, v1, s[90:91] offset:3584
    v_lshlrev_b32 v24, 4, v0
    s_add_u32 s90, s12, 262144
    s_addc_u32 s91, s13, 0
    global_load_dwordx4 v[24:27], v24, s[90:91]
    s_add_u32 s90, s14, 0
    s_addc_u32 s91, s15, 0
    global_load_dword v192, v1, s[90:91] offset:0
    global_load_dword v196, v1, s[90:91] offset:512
    global_load_dword v193, v1, s[90:91] offset:1024
    s_waitcnt vmcnt(50)
    global_load_dword v197, v1, s[90:91] offset:1536
    global_load_dword v194, v1, s[90:91] offset:2048
    global_load_dword v198, v1, s[90:91] offset:2560
    global_load_dword v195, v1, s[90:91] offset:3072
    global_load_dword v199, v1, s[90:91] offset:3584
    s_add_u32 s90, s14, 16384
    s_addc_u32 s91, s15, 0
    global_load_dword v200, v1, s[90:91] offset:0
    global_load_dword v204, v1, s[90:91] offset:512
    s_waitcnt vmcnt(50)
    global_load_dword v201, v1, s[90:91] offset:1024
    global_load_dword v205, v1, s[90:91] offset:1536
    global_load_dword v202, v1, s[90:91] offset:2048
    global_load_dword v206, v1, s[90:91] offset:2560
    global_load_dword v203, v1, s[90:91] offset:3072
    global_load_dword v207, v1, s[90:91] offset:3584
    s_add_u32 s90, s14, 32768
    s_addc_u32 s91, s15, 0
    global_load_dword v208, v1, s[90:91] offset:0
    s_waitcnt vmcnt(50)
    global_load_dword v212, v1, s[90:91] offset:512
    global_load_dword v209, v1, s[90:91] offset:1024
    global_load_dword v213, v1, s[90:91] offset:1536
    global_load_dword v210, v1, s[90:91] offset:2048
    global_load_dword v214, v1, s[90:91] offset:2560
    global_load_dword v211, v1, s[90:91] offset:3072
    global_load_dword v215, v1, s[90:91] offset:3584
    ds_read_b128 v[104:107], v2 offset:0
    ds_read_b128 v[108:111], v2 offset:8704
    ds_read_b128 v[112:115], v2 offset:17408
    ds_read_b128 v[116:119], v2 offset:26112
    ds_read_b128 v[120:123], v2 offset:34816
    v_perm_b32 v36, v44, v40, s76
    v_perm_b32 v44, v44, v40, s77
    v_perm_b32 v37, v45, v41, s76
    v_perm_b32 v45, v45, v41, s77
    v_perm_b32 v38, v46, v42, s76
    v_perm_b32 v46, v46, v42, s77
    v_perm_b32 v39, v47, v43, s76
    v_perm_b32 v47, v47, v43, s77
    s_waitcnt lgkmcnt(0)
    v_mfma_f32_16x16x32_bf16 v[144:147], v[36:39], v[104:107], 0
    ds_read_b128 v[124:127], v2 offset:64
    v_mfma_f32_16x16x32_bf16 v[152:155], v[36:39], v[108:111], 0
    ds_read_b128 v[128:131], v2 offset:8768
    v_mfma_f32_16x16x32_bf16 v[160:163], v[36:39], v[112:115], 0
    ds_read_b128 v[132:135], v2 offset:17472
    v_mfma_f32_16x16x32_bf16 v[168:171], v[36:39], v[116:119], 0
    ds_read_b128 v[136:139], v2 offset:26176
    v_mfma_f32_16x16x32_bf16 v[176:179], v[36:39], v[120:123], 0
    ds_read_b128 v[140:143], v2 offset:34880
    v_mfma_f32_16x16x32_bf16 v[148:151], v[44:47], v[104:107], 0
    v_perm_b32 v40, v52, v48, s76
    v_perm_b32 v52, v52, v48, s77
    v_mfma_f32_16x16x32_bf16 v[156:159], v[44:47], v[108:111], 0
    v_perm_b32 v41, v53, v49, s76
    v_perm_b32 v53, v53, v49, s77
    v_mfma_f32_16x16x32_bf16 v[164:167], v[44:47], v[112:115], 0
    v_perm_b32 v42, v54, v50, s76
    v_perm_b32 v54, v54, v50, s77
    v_mfma_f32_16x16x32_bf16 v[172:175], v[44:47], v[116:119], 0
    v_perm_b32 v43, v55, v51, s76
    v_perm_b32 v55, v55, v51, s77
    v_mfma_f32_16x16x32_bf16 v[180:183], v[44:47], v[120:123], 0
    s_waitcnt lgkmcnt(0)
    v_mfma_f32_16x16x32_bf16 v[144:147], v[40:43], v[124:127], v[144:147]
    ds_read_b128 v[104:107], v2 offset:128
    v_mfma_f32_16x16x32_bf16 v[152:155], v[40:43], v[128:131], v[152:155]
    ds_read_b128 v[108:111], v2 offset:8832
    v_mfma_f32_16x16x32_bf16 v[160:163], v[40:43], v[132:135], v[160:163]
    ds_read_b128 v[112:115], v2 offset:17536
    v_mfma_f32_16x16x32_bf16 v[168:171], v[40:43], v[136:139], v[168:171]
    ds_read_b128 v[116:119], v2 offset:26240
    v_mfma_f32_16x16x32_bf16 v[176:179], v[40:43], v[140:143], v[176:179]
    ds_read_b128 v[120:123], v2 offset:34944
    v_mfma_f32_16x16x32_bf16 v[148:151], v[52:55], v[124:127], v[148:151]
    v_perm_b32 v48, v60, v56, s76
    v_perm_b32 v60, v60, v56, s77
    v_mfma_f32_16x16x32_bf16 v[156:159], v[52:55], v[128:131], v[156:159]
    v_perm_b32 v49, v61, v57, s76
    v_perm_b32 v61, v61, v57, s77
    v_mfma_f32_16x16x32_bf16 v[164:167], v[52:55], v[132:135], v[164:167]
    v_perm_b32 v50, v62, v58, s76
    v_perm_b32 v62, v62, v58, s77
    v_mfma_f32_16x16x32_bf16 v[172:175], v[52:55], v[136:139], v[172:175]
    v_perm_b32 v51, v63, v59, s76
    v_perm_b32 v63, v63, v59, s77
    v_mfma_f32_16x16x32_bf16 v[180:183], v[52:55], v[140:143], v[180:183]
    s_waitcnt lgkmcnt(0)
    v_mfma_f32_16x16x32_bf16 v[144:147], v[48:51], v[104:107], v[144:147]
    ds_read_b128 v[124:127], v2 offset:192
    v_mfma_f32_16x16x32_bf16 v[152:155], v[48:51], v[108:111], v[152:155]
    ds_read_b128 v[128:131], v2 offset:8896
    v_mfma_f32_16x16x32_bf16 v[160:163], v[48:51], v[112:115], v[160:163]
    ds_read_b128 v[132:135], v2 offset:17600
    v_mfma_f32_16x16x32_bf16 v[168:171], v[48:51], v[116:119], v[168:171]
    ds_read_b128 v[136:139], v2 offset:26304
    v_mfma_f32_16x16x32_bf16 v[176:179], v[48:51], v[120:123], v[176:179]
    ds_read_b128 v[140:143], v2 offset:35008
    v_mfma_f32_16x16x32_bf16 v[148:151], v[60:63], v[104:107], v[148:151]
    s_waitcnt vmcnt(57)
    v_perm_b32 v56, v68, v64, s76
    v_perm_b32 v68, v68, v64, s77
    v_mfma_f32_16x16x32_bf16 v[156:159], v[60:63], v[108:111], v[156:159]
    v_perm_b32 v57, v69, v65, s76
    v_perm_b32 v69, v69, v65, s77
    v_mfma_f32_16x16x32_bf16 v[164:167], v[60:63], v[112:115], v[164:167]
    v_perm_b32 v58, v70, v66, s76
    v_perm_b32 v70, v70, v66, s77
    v_mfma_f32_16x16x32_bf16 v[172:175], v[60:63], v[116:119], v[172:175]
    v_perm_b32 v59, v71, v67, s76
    v_perm_b32 v71, v71, v67, s77
    v_mfma_f32_16x16x32_bf16 v[180:183], v[60:63], v[120:123], v[180:183]
    s_waitcnt lgkmcnt(0)
    v_mfma_f32_16x16x32_bf16 v[144:147], v[56:59], v[124:127], v[144:147]
    ds_read_b128 v[104:107], v2 offset:256
    v_mfma_f32_16x16x32_bf16 v[152:155], v[56:59], v[128:131], v[152:155]
    ds_read_b128 v[108:111], v2 offset:8960
    v_mfma_f32_16x16x32_bf16 v[160:163], v[56:59], v[132:135], v[160:163]
    ds_read_b128 v[112:115], v2 offset:17664
    v_mfma_f32_16x16x32_bf16 v[168:171], v[56:59], v[136:139], v[168:171]
    ds_read_b128 v[116:119], v2 offset:26368
    v_mfma_f32_16x16x32_bf16 v[176:179], v[56:59], v[140:143], v[176:179]
    ds_read_b128 v[120:123], v2 offset:35072
    v_mfma_f32_16x16x32_bf16 v[148:151], v[68:71], v[124:127], v[148:151]
    s_waitcnt vmcnt(49)
    v_perm_b32 v64, v76, v72, s76
    v_perm_b32 v76, v76, v72, s77
    v_mfma_f32_16x16x32_bf16 v[156:159], v[68:71], v[128:131], v[156:159]
    v_perm_b32 v65, v77, v73, s76
    v_perm_b32 v77, v77, v73, s77
    v_mfma_f32_16x16x32_bf16 v[164:167], v[68:71], v[132:135], v[164:167]
    v_perm_b32 v66, v78, v74, s76
    v_perm_b32 v78, v78, v74, s77
    v_mfma_f32_16x16x32_bf16 v[172:175], v[68:71], v[136:139], v[172:175]
    v_perm_b32 v67, v79, v75, s76
    v_perm_b32 v79, v79, v75, s77
    v_mfma_f32_16x16x32_bf16 v[180:183], v[68:71], v[140:143], v[180:183]
    s_waitcnt lgkmcnt(0)
    v_mfma_f32_16x16x32_bf16 v[144:147], v[64:67], v[104:107], v[144:147]
    ds_read_b128 v[124:127], v2 offset:320
    v_mfma_f32_16x16x32_bf16 v[152:155], v[64:67], v[108:111], v[152:155]
    ds_read_b128 v[128:131], v2 offset:9024
    v_mfma_f32_16x16x32_bf16 v[160:163], v[64:67], v[112:115], v[160:163]
    ds_read_b128 v[132:135], v2 offset:17728
    v_mfma_f32_16x16x32_bf16 v[168:171], v[64:67], v[116:119], v[168:171]
    ds_read_b128 v[136:139], v2 offset:26432
    v_mfma_f32_16x16x32_bf16 v[176:179], v[64:67], v[120:123], v[176:179]
    ds_read_b128 v[140:143], v2 offset:35136
    v_mfma_f32_16x16x32_bf16 v[148:151], v[76:79], v[104:107], v[148:151]
    s_waitcnt vmcnt(41)
    v_perm_b32 v72, v84, v80, s76
    v_perm_b32 v84, v84, v80, s77
    v_mfma_f32_16x16x32_bf16 v[156:159], v[76:79], v[108:111], v[156:159]
    v_perm_b32 v73, v85, v81, s76
    v_perm_b32 v85, v85, v81, s77
    v_mfma_f32_16x16x32_bf16 v[164:167], v[76:79], v[112:115], v[164:167]
    v_perm_b32 v74, v86, v82, s76
    v_perm_b32 v86, v86, v82, s77
    v_mfma_f32_16x16x32_bf16 v[172:175], v[76:79], v[116:119], v[172:175]
    v_perm_b32 v75, v87, v83, s76
    v_perm_b32 v87, v87, v83, s77
    v_mfma_f32_16x16x32_bf16 v[180:183], v[76:79], v[120:123], v[180:183]
    s_waitcnt lgkmcnt(0)
    v_mfma_f32_16x16x32_bf16 v[144:147], v[72:75], v[124:127], v[144:147]
    ds_read_b128 v[104:107], v2 offset:384
    v_mfma_f32_16x16x32_bf16 v[152:155], v[72:75], v[128:131], v[152:155]
    ds_read_b128 v[108:111], v2 offset:9088
    v_mfma_f32_16x16x32_bf16 v[160:163], v[72:75], v[132:135], v[160:163]
    ds_read_b128 v[112:115], v2 offset:17792
    v_mfma_f32_16x16x32_bf16 v[168:171], v[72:75], v[136:139], v[168:171]
    ds_read_b128 v[116:119], v2 offset:26496
    v_mfma_f32_16x16x32_bf16 v[176:179], v[72:75], v[140:143], v[176:179]
    ds_read_b128 v[120:123], v2 offset:35200
    v_mfma_f32_16x16x32_bf16 v[148:151], v[84:87], v[124:127], v[148:151]
    s_waitcnt vmcnt(33)
    v_perm_b32 v80, v92, v88, s76
    v_perm_b32 v92, v92, v88, s77
    v_mfma_f32_16x16x32_bf16 v[156:159], v[84:87], v[128:131], v[156:159]
    v_perm_b32 v81, v93, v89, s76
    v_perm_b32 v93, v93, v89, s77
    v_mfma_f32_16x16x32_bf16 v[164:167], v[84:87], v[132:135], v[164:167]
    v_perm_b32 v82, v94, v90, s76
    v_perm_b32 v94, v94, v90, s77
    v_mfma_f32_16x16x32_bf16 v[172:175], v[84:87], v[136:139], v[172:175]
    v_perm_b32 v83, v95, v91, s76
    v_perm_b32 v95, v95, v91, s77
    v_mfma_f32_16x16x32_bf16 v[180:183], v[84:87], v[140:143], v[180:183]
    s_waitcnt lgkmcnt(0)
    v_mfma_f32_16x16x32_bf16 v[144:147], v[80:83], v[104:107], v[144:147]
    ds_read_b128 v[124:127], v2 offset:448
    v_mfma_f32_16x16x32_bf16 v[152:155], v[80:83], v[108:111], v[152:155]
    ds_read_b128 v[128:131], v2 offset:9152
    v_mfma_f32_16x16x32_bf16 v[160:163], v[80:83], v[112:115], v[160:163]
    ds_read_b128 v[132:135], v2 offset:17856
    v_mfma_f32_16x16x32_bf16 v[168:171], v[80:83], v[116:119], v[168:171]
    ds_read_b128 v[136:139], v2 offset:26560
    v_mfma_f32_16x16x32_bf16 v[176:179], v[80:83], v[120:123], v[176:179]
    ds_read_b128 v[140:143], v2 offset:35264
    v_mfma_f32_16x16x32_bf16 v[148:151], v[92:95], v[104:107], v[148:151]
    s_waitcnt vmcnt(25)
    v_perm_b32 v88, v100, v96, s76
    v_perm_b32 v100, v100, v96, s77
    v_mfma_f32_16x16x32_bf16 v[156:159], v[92:95], v[108:111], v[156:159]
    v_perm_b32 v89, v101, v97, s76
    v_perm_b32 v101, v101, v97, s77
    v_mfma_f32_16x16x32_bf16 v[164:167], v[92:95], v[112:115], v[164:167]
    v_perm_b32 v90, v102, v98, s76
    v_perm_b32 v102, v102, v98, s77
    v_mfma_f32_16x16x32_bf16 v[172:175], v[92:95], v[116:119], v[172:175]
    v_perm_b32 v91, v103, v99, s76
    v_perm_b32 v103, v103, v99, s77
    v_mfma_f32_16x16x32_bf16 v[180:183], v[92:95], v[120:123], v[180:183]
    s_waitcnt lgkmcnt(0)
    v_mfma_f32_16x16x32_bf16 v[144:147], v[88:91], v[124:127], v[144:147]
    v_mfma_f32_16x16x32_bf16 v[152:155], v[88:91], v[128:131], v[152:155]
    v_mfma_f32_16x16x32_bf16 v[160:163], v[88:91], v[132:135], v[160:163]
    v_mfma_f32_16x16x32_bf16 v[168:171], v[88:91], v[136:139], v[168:171]
    v_mfma_f32_16x16x32_bf16 v[176:179], v[88:91], v[140:143], v[176:179]
    v_mfma_f32_16x16x32_bf16 v[148:151], v[100:103], v[124:127], v[148:151]
    v_mfma_f32_16x16x32_bf16 v[156:159], v[100:103], v[128:131], v[156:159]
    v_mfma_f32_16x16x32_bf16 v[164:167], v[100:103], v[132:135], v[164:167]
    v_mfma_f32_16x16x32_bf16 v[172:175], v[100:103], v[136:139], v[172:175]
    v_mfma_f32_16x16x32_bf16 v[180:183], v[100:103], v[140:143], v[180:183]
    buffer_load_dwordx4 v[8:11], v28, s[64:67], s80 offen offset:0 sc1
    buffer_load_dwordx4 v[12:15], v28, s[64:67], s80 offen offset:32 sc1
    s_nop 7
    s_mov_b32 s86, 0xd3b8aa3b
    s_mov_b32 s87, 0xd3b8aa3b
    v_pk_mul_f32 v[144:145], v[144:145], s[86:87]
    v_pk_mul_f32 v[146:147], v[146:147], s[86:87]
    v_pk_mul_f32 v[148:149], v[148:149], s[86:87]
    v_pk_mul_f32 v[150:151], v[150:151], s[86:87]
    v_cvt_pk_bf16_f32 v144, v144, v148
    v_cvt_pk_bf16_f32 v145, v145, v149
    v_cvt_pk_bf16_f32 v146, v146, v150
    v_cvt_pk_bf16_f32 v147, v147, v151
    ds_write_b128 v3, v[144:147] offset:17408
    v_pk_mul_f32 v[152:153], v[152:153], s[86:87]
    v_pk_mul_f32 v[154:155], v[154:155], s[86:87]
    v_pk_mul_f32 v[156:157], v[156:157], s[86:87]
    v_pk_mul_f32 v[158:159], v[158:159], s[86:87]
    v_cvt_pk_bf16_f32 v152, v152, v156
    v_cvt_pk_bf16_f32 v153, v153, v157
    v_cvt_pk_bf16_f32 v154, v154, v158
    v_cvt_pk_bf16_f32 v155, v155, v159
    ds_write_b128 v3, v[152:155] offset:26112
    v_pk_mul_f32 v[160:161], v[160:161], s[86:87]
    v_pk_mul_f32 v[162:163], v[162:163], s[86:87]
    v_pk_mul_f32 v[164:165], v[164:165], s[86:87]
    v_pk_mul_f32 v[166:167], v[166:167], s[86:87]
    v_cvt_pk_bf16_f32 v160, v160, v164
    v_cvt_pk_bf16_f32 v161, v161, v165
    v_cvt_pk_bf16_f32 v162, v162, v166
    v_cvt_pk_bf16_f32 v163, v163, v167
    ds_write_b128 v3, v[160:163] offset:34816
    v_pk_mul_f32 v[168:169], v[168:169], s[86:87]
    v_pk_mul_f32 v[170:171], v[170:171], s[86:87]
    v_pk_mul_f32 v[172:173], v[172:173], s[86:87]
    v_pk_mul_f32 v[174:175], v[174:175], s[86:87]
    v_cvt_pk_bf16_f32 v168, v168, v172
    v_cvt_pk_bf16_f32 v169, v169, v173
    v_cvt_pk_bf16_f32 v170, v170, v174
    v_cvt_pk_bf16_f32 v171, v171, v175
    ds_write_b128 v3, v[168:171] offset:43520
    v_pk_mul_f32 v[176:177], v[176:177], s[86:87]
    v_pk_mul_f32 v[178:179], v[178:179], s[86:87]
    v_pk_mul_f32 v[180:181], v[180:181], s[86:87]
    v_pk_mul_f32 v[182:183], v[182:183], s[86:87]
    v_cvt_pk_bf16_f32 v176, v176, v180
    v_cvt_pk_bf16_f32 v177, v177, v181
    v_cvt_pk_bf16_f32 v178, v178, v182
    v_cvt_pk_bf16_f32 v179, v179, v183
    ds_write_b128 v3, v[176:179] offset:52224
    s_mov_b32 s86, 0xbfb8aa3b
    s_mov_b32 s87, 0xbfb8aa3b
    s_waitcnt vmcnt(26)
    v_lshlrev_b32 v16, 16, v24
    v_and_b32 v17, 0xffff0000, v24
    v_lshlrev_b32 v18, 16, v25
    v_and_b32 v19, 0xffff0000, v25
    v_lshlrev_b32 v20, 16, v26
    v_and_b32 v21, 0xffff0000, v26
    v_lshlrev_b32 v22, 16, v27
    v_and_b32 v23, 0xffff0000, v27
    v_pk_mul_f32 v[16:17], v[16:17], s[86:87]
    v_pk_mul_f32 v[18:19], v[18:19], s[86:87]
    v_pk_mul_f32 v[20:21], v[20:21], s[86:87]
    v_pk_mul_f32 v[22:23], v[22:23], s[86:87]
    v_cvt_pk_bf16_f32 v24, v16, v17
    v_cvt_pk_bf16_f32 v25, v18, v19
    v_cvt_pk_bf16_f32 v26, v20, v21
    v_cvt_pk_bf16_f32 v27, v22, v23
    s_mul_i32 s72, s70, 43776
    v_add_u32 v16, s72, v4
    ds_write_b128 v16, v[24:27] offset:60928
    v_bfe_u32 v134, v0, 5, 1
    v_bfe_u32 v135, v0, 4, 1
    v_bfe_u32 v136, v0, 2, 2
    v_and_b32 v137, 3, v0
    v_lshlrev_b32 v138, 3, v137
    v_lshl_add_u32 v138, v135, 5, v138
    v_lshl_add_u32 v139, v134, 3, v136
    s_lshr_b32 s41, s69, 1
    s_xor_b32 s41, s41, s2
    s_and_b32 s41, s41, 1
    s_lshl_b32 s71, s41, 1
    s_add_u32 s71, s71, s70
    s_mul_i32 s71, s71, 10880
    s_and_b32 s72, s78, 128
    s_add_u32 s71, s71, s72
    v_mul_u32_u24 v6, 544, v139
    v_mul_u32_u24 v7, 544, v136
    v_mul_u32_u24 v141, 48128, v134
    v_add3_u32 v141, v141, v138, s78
    v_add_u32 v141, v141, v7
    v_add3_u32 v6, v6, v138, s71
    v_add3_u32 v7, v7, v138, s71
    s_waitcnt vmcnt(0)
    s_waitcnt vmcnt(40) lgkmcnt(0)
L_merge:
    s_barrier
    v_mov_b32 v154, v28
    ds_read_b64_tr_b16 v[24:25], v6 offset:17664
    ds_read_b64_tr_b16 v[26:27], v6 offset:19840
    ds_read_b64_tr_b16 v[28:29], v6 offset:17728
    ds_read_b64_tr_b16 v[30:31], v6 offset:19904
    ds_read_b64_tr_b16 v[32:33], v7 offset:26368
    ds_read_b64_tr_b16 v[34:35], v7 offset:26432
    ds_read_b64_tr_b16 v[16:17], v141 offset:60928
    ds_read_b64_tr_b16 v[18:19], v141 offset:63104
    ds_read_b64_tr_b16 v[20:21], v141 offset:60992
    ds_read_b64_tr_b16 v[22:23], v141 offset:63168
    v_lshrrev_b32 v140, 1, v136
    v_lshlrev_b32 v162, 7, v139
    v_lshl_add_u32 v162, v140, 6, v162
    v_add3_u32 v162, v162, v138, s79
    v_xor_b32 v163, 64, v162
    v_lshrrev_b32 v152, 1, v0
    v_mul_u32_u24 v152, 640, v152
    s_and_b32 s71, s69, 1
    s_lshl_b32 s72, s70, 1
    s_add_u32 s40, s71, s72
    s_lshl_b32 s72, s2, 2
    s_add_u32 s71, s40, s72
    s_mul_i32 s71, s71, 3328
    v_and_b32 v60, 63, v0
    v_lshl_add_u32 v61, v60, 2, s71
    v_lshl_add_u32 v60, v60, 4, s71
    s_cmp_eq_u32 s41, 0
    s_cbranch_scc1 L_noqs
    s_waitcnt lgkmcnt(4)
    v_xor_b32 v62, s3, v24
    v_bitop3_b32 v62, v62, v25, v26 bitop3:0x96
    v_bitop3_b32 v62, v62, v27, v28 bitop3:0x96
    v_bitop3_b32 v62, v62, v29, v30 bitop3:0x96
    v_bitop3_b32 v62, v62, v31, v32 bitop3:0x96
    v_bitop3_b32 v62, v62, v33, v34 bitop3:0x96
    v_xor_b32 v62, v62, v35
    s_mul_i32 s72, s3, 3
    v_xor_b32 v24, s72, v24
    s_mul_i32 s72, s3, 5
    v_xor_b32 v28, s72, v28
    s_mul_i32 s72, s3, 7
    v_xor_b32 v32, s72, v32
    buffer_store_dwordx4 v[24:27], v60, s[44:47], 0 offen offset:0 sc1
    buffer_store_dwordx4 v[28:31], v60, s[44:47], 0 offen offset:1024 sc1
    buffer_store_dwordx4 v[32:35], v60, s[44:47], 0 offen offset:2048 sc1
    buffer_store_dword v62, v61, s[44:47], 0 offen offset:3072 sc1
    s_bitcmp1_b32 s2, 0
    s_mov_b32 s71, 13312
    s_cselect_b32 s71, -13312, s71
    v_add_u32 v60, s71, v60
    v_add_u32 v61, s71, v61
L_noqs:
    s_mov_b32 s71, 0
    v_and_b32 v104, 1, v0
    v_lshl_add_u32 v104, v104, 1, 3
    v_mul_lo_u32 v104, v104, s3
    v_lshl_add_u32 v105, s3, 2, v104
L_cverify:
    v_xor_b32 v8, v8, v104
    v_xor_b32 v12, v12, v105
    v_bitop3_b32 v6, v8, v9, v10 bitop3:0x96
    v_bitop3_b32 v7, v11, v12, v13 bitop3:0x96
    v_bitop3_b32 v6, v6, v14, v15 bitop3:0x96
    v_xor_b32 v6, v6, v7
    s_add_u32 s71, s71, 1
    s_cmp_gt_u32 s71, 0x20000
    v_xor_b32_dpp v6, v6, v6 quad_perm:[1,0,3,2] row_mask:0xf bank_mask:0xf
    v_cmp_ne_u32 vcc, s3, v6
    s_cbranch_scc1 L_cok
    s_cbranch_vccz L_cok
    s_mov_b64 exec, vcc
    buffer_load_dwordx4 v[8:11], v154, s[64:67], s80 offen offset:0 sc1
    buffer_load_dwordx4 v[12:15], v154, s[64:67], s80 offen offset:32 sc1
    s_waitcnt vmcnt(0)
    s_branch L_cverify
L_cok:
    s_mov_b64 exec, -1
    v_cmp_gt_u32 vcc, 500, v0
    s_mov_b32 s88, 0xaaaaaaaa
    s_mov_b32 s89, 0xaaaaaaaa
    v_cndmask_b32 v8, -1, v8, vcc
    v_cndmask_b32 v9, -1, v9, vcc
    v_cndmask_b32 v10, -1, v10, vcc
    v_cndmask_b32 v11, -1, v11, vcc
    v_cndmask_b32 v12, -1, v12, vcc
    v_cndmask_b32 v15, v15, -1, s[88:89]
    v_mov_b32 v105, 1
    v_cmpx_le_i32 vcc, 0, v8
    v_bfe_u32 v104, v8, 14, 6
    v_lshlrev_b32 v104, 2, v104
    v_add_u32 v104, 161296, v104
    ds_add_rtn_u32 v144, v104, v105
    s_mov_b64 exec, -1
    s_add_u32 s90, s14, 49152
    s_addc_u32 s91, s15, 0
    global_load_dword v216, v1, s[90:91] offset:0
    global_load_dword v220, v1, s[90:91] offset:512
    global_load_dword v217, v1, s[90:91] offset:1024
    v_cmpx_le_i32 vcc, 0, v9
    v_bfe_u32 v104, v9, 14, 6
    v_lshlrev_b32 v104, 2, v104
    v_add_u32 v104, 161296, v104
    ds_add_rtn_u32 v145, v104, v105
    s_mov_b64 exec, -1
    global_load_dword v221, v1, s[90:91] offset:1536
    global_load_dword v218, v1, s[90:91] offset:2048
    global_load_dword v222, v1, s[90:91] offset:2560
    v_cmpx_le_i32 vcc, 0, v10
    v_bfe_u32 v104, v10, 14, 6
    v_lshlrev_b32 v104, 2, v104
    v_add_u32 v104, 161296, v104
    ds_add_rtn_u32 v146, v104, v105
    s_mov_b64 exec, -1
    global_load_dword v219, v1, s[90:91] offset:3072
    global_load_dword v223, v1, s[90:91] offset:3584
    s_add_u32 s90, s14, 65536
    s_addc_u32 s91, s15, 0
    global_load_dword v224, v1, s[90:91] offset:0
    v_cmpx_le_i32 vcc, 0, v11
    v_bfe_u32 v104, v11, 14, 6
    v_lshlrev_b32 v104, 2, v104
    v_add_u32 v104, 161296, v104
    ds_add_rtn_u32 v147, v104, v105
    s_mov_b64 exec, -1
    global_load_dword v228, v1, s[90:91] offset:512
    global_load_dword v225, v1, s[90:91] offset:1024
    global_load_dword v229, v1, s[90:91] offset:1536
    s_mov_b64 exec, -1
    v_cmp_le_i32 vcc, 0, v12
    s_cmp_lg_u64 vcc, 0
    s_cselect_b32 s80, 1, 0
    s_cbranch_scc0 L_norare1
    v_mov_b32 v105, 1
    v_cmpx_le_i32 vcc, 0, v12
    v_bfe_u32 v104, v12, 14, 6
    v_lshlrev_b32 v104, 2, v104
    v_add_u32 v104, 161296, v104
    ds_add_rtn_u32 v148, v104, v105
    v_cmpx_le_i32 vcc, 0, v13
    v_bfe_u32 v104, v13, 14, 6
    v_lshlrev_b32 v104, 2, v104
    v_add_u32 v104, 161296, v104
    ds_add_rtn_u32 v149, v104, v105
    v_cmpx_le_i32 vcc, 0, v14
    v_bfe_u32 v104, v14, 14, 6
    v_lshlrev_b32 v104, 2, v104
    v_add_u32 v104, 161296, v104
    ds_add_rtn_u32 v150, v104, v105
    v_cmpx_le_i32 vcc, 0, v15
    v_bfe_u32 v104, v15, 14, 6
    v_lshlrev_b32 v104, 2, v104
    v_add_u32 v104, 161296, v104
    ds_add_rtn_u32 v151, v104, v105
    s_mov_b64 exec, -1
    v_bfrev_b32 v6, 1
    v_cmpx_eq_u32 vcc, v6, v14
    v_mov_b32 v6, 161552
    v_mov_b32 v7, 1
    ds_write_b32 v6, v7
    s_mov_b64 exec, -1
L_norare1:
    s_waitcnt lgkmcnt(0)
    s_barrier
    v_and_b32 v6, 31, v0
    v_lshl_add_u32 v6, s68, 5, v6
    v_min_u32 v6, 249, v6
    v_lshlrev_b32 v63, 6, v6
    global_load_dword v226, v1, s[90:91] offset:2048
    global_load_dword v230, v1, s[90:91] offset:2560
    global_load_dword v227, v1, s[90:91] offset:3072
    global_load_dword v231, v1, s[90:91] offset:3584
    v_and_b32 v104, 63, v0
    v_lshlrev_b32 v104, 2, v104
    v_add_u32 v104, 161296, v104
    ds_read_b32 v105, v104
    v_mov_b32 v104, 161552
    ds_read_b32 v106, v104
    s_add_u32 s90, s14, 81920
    s_addc_u32 s91, s15, 0
    global_load_dword v232, v1, s[90:91] offset:0
    global_load_dword v236, v1, s[90:91] offset:512
    s_waitcnt vmcnt(50)
    global_load_dword v233, v1, s[90:91] offset:1024
    global_load_dword v237, v1, s[90:91] offset:1536
    global_load_dword v234, v1, s[90:91] offset:2048
    global_load_dword v238, v1, s[90:91] offset:2560
    s_waitcnt lgkmcnt(0)
    v_add_u32 v105, 1, v105
    v_and_b32 v105, -2, v105
    v_mov_b32 v153, v105
    s_nop 1
    v_add_u32_dpp v153, v153, v153 row_shr:1 row_mask:0xf bank_mask:0xf bound_ctrl:0
    s_nop 1
    v_add_u32_dpp v153, v153, v153 row_shr:2 row_mask:0xf bank_mask:0xf bound_ctrl:0
    s_nop 1
    v_add_u32_dpp v153, v153, v153 row_shr:4 row_mask:0xf bank_mask:0xf bound_ctrl:0
    s_nop 1
    v_add_u32_dpp v153, v153, v153 row_shr:8 row_mask:0xf bank_mask:0xf bound_ctrl:0
    s_nop 1
    v_add_u32_dpp v153, v153, v153 row_bcast:15 row_mask:0xa bank_mask:0xf
    s_nop 0
    v_readlane_b32 s71, v153, 31
    v_readlane_b32 s72, v153, 63
    v_readfirstlane_b32 s73, v106
    v_readlane_b32 s42, v153, 15
    v_readlane_b32 s43, v153, 47
    v_sub_u32 v153, v153, v105
    s_mov_b32 exec_lo, 0
    v_add_u32 v153, 416, v153
    s_mov_b32 exec_lo, -1
    s_cmp_eq_u32 s70, 0
    s_cselect_b32 s74, s71, s72
    s_cselect_b32 s42, s42, s43
    s_sub_u32 s43, s74, 1
    s_add_u32 s74, s74, 31
    s_lshr_b32 s74, s74, 5
    s_max_u32 s71, s71, s72
    s_cmp_gt_u32 s71, 416
    s_cselect_b32 s81, 1, 0
    s_or_b32 s81, s81, s73
    s_cbranch_scc0 L_scat
    s_mov_b32 s80, 0
    v_mov_b32 v8, -1
    v_mov_b32 v9, -1
    v_mov_b32 v10, -1
    v_mov_b32 v11, -1
L_scat:
    s_mov_b32 exec_hi, 0
    buffer_load_dwordx4 v[64:67], v63, s[52:55], 0 offen sc1
    s_mov_b32 exec_hi, -1
    v_bfe_u32 v104, v8, 14, 6
    v_lshlrev_b32 v108, 2, v104
    ds_bpermute_b32 v108, v108, v153
    v_bfe_u32 v105, v9, 14, 6
    v_lshlrev_b32 v109, 2, v105
    ds_bpermute_b32 v109, v109, v153
    v_bfe_u32 v106, v10, 14, 6
    v_lshlrev_b32 v110, 2, v106
    ds_bpermute_b32 v110, v110, v153
    v_bfe_u32 v107, v11, 14, 6
    v_lshlrev_b32 v111, 2, v107
    ds_bpermute_b32 v111, v111, v153
    global_load_dword v235, v1, s[90:91] offset:3072
    global_load_dword v239, v1, s[90:91] offset:3584
    s_waitcnt vmcnt(50)
    s_add_u32 s90, s14, 98304
    s_addc_u32 s91, s15, 0
    global_load_dword v240, v1, s[90:91] offset:0
    global_load_dword v244, v1, s[90:91] offset:512
    global_load_dword v241, v1, s[90:91] offset:1024
    global_load_dword v245, v1, s[90:91] offset:1536
    s_mov_b32 s83, 0xd8d8d8d8
    v_mov_b32 v116, 0x2b80
    s_waitcnt lgkmcnt(0)
    v_cmpx_le_i32 vcc, 0, v8
    v_add_u32 v108, v108, v144
    v_lshlrev_b32 v112, 1, v108
    v_bfe_u32 v112, s83, v112, 2
    v_bfi_b32 v108, 3, v112, v108
    v_and_b32 v114, 0x3fff, v8
    v_lshrrev_b32 v115, 20, v8
    v_add_u32 v115, v115, v152
    v_lshlrev_b32 v112, 3, v108
    v_add_u32 v112, 153872, v112
    ds_write_b64 v112, v[114:115]
    v_and_b32 v113, 31, v104
    v_mad_u32_u24 v113, v108, 24, v113
    v_lshlrev_b32 v113, 1, v113
    v_add_u32 v113, 113920, v113
    ds_write_b16 v113, v116
    s_mov_b64 exec, -1
    global_load_dword v242, v1, s[90:91] offset:2048
    global_load_dword v246, v1, s[90:91] offset:2560
    global_load_dword v243, v1, s[90:91] offset:3072
    v_cmpx_le_i32 vcc, 0, v9
    v_add_u32 v109, v109, v145
    v_lshlrev_b32 v112, 1, v109
    v_bfe_u32 v112, s83, v112, 2
    v_bfi_b32 v109, 3, v112, v109
    v_and_b32 v114, 0x3fff, v9
    v_lshrrev_b32 v115, 20, v9
    v_add_u32 v115, v115, v152
    v_lshlrev_b32 v112, 3, v109
    v_add_u32 v112, 153872, v112
    ds_write_b64 v112, v[114:115]
    v_and_b32 v113, 31, v105
    v_mad_u32_u24 v113, v109, 24, v113
    v_lshlrev_b32 v113, 1, v113
    v_add_u32 v113, 113920, v113
    ds_write_b16 v113, v116
    s_mov_b64 exec, -1
    s_waitcnt vmcnt(50)
    global_load_dword v247, v1, s[90:91] offset:3584
    s_add_u32 s90, s14, 114688
    s_addc_u32 s91, s15, 0
    global_load_dword v248, v1, s[90:91] offset:0
    global_load_dword v252, v1, s[90:91] offset:512
    v_cmpx_le_i32 vcc, 0, v10
    v_add_u32 v110, v110, v146
    v_lshlrev_b32 v112, 1, v110
    v_bfe_u32 v112, s83, v112, 2
    v_bfi_b32 v110, 3, v112, v110
    v_and_b32 v114, 0x3fff, v10
    v_lshrrev_b32 v115, 20, v10
    v_add_u32 v115, v115, v152
    v_lshlrev_b32 v112, 3, v110
    v_add_u32 v112, 153872, v112
    ds_write_b64 v112, v[114:115]
    v_and_b32 v113, 31, v106
    v_mad_u32_u24 v113, v110, 24, v113
    v_lshlrev_b32 v113, 1, v113
    v_add_u32 v113, 113920, v113
    ds_write_b16 v113, v116
    s_mov_b64 exec, -1
    global_load_dword v249, v1, s[90:91] offset:1024
    global_load_dword v253, v1, s[90:91] offset:1536
    global_load_dword v250, v1, s[90:91] offset:2048
    v_cmpx_le_i32 vcc, 0, v11
    v_add_u32 v111, v111, v147
    v_lshlrev_b32 v112, 1, v111
    v_bfe_u32 v112, s83, v112, 2
    v_bfi_b32 v111, 3, v112, v111
    v_and_b32 v114, 0x3fff, v11
    v_lshrrev_b32 v115, 20, v11
    v_add_u32 v115, v115, v152
    v_lshlrev_b32 v112, 3, v111
    v_add_u32 v112, 153872, v112
    ds_write_b64 v112, v[114:115]
    v_and_b32 v113, 31, v107
    v_mad_u32_u24 v113, v111, 24, v113
    v_lshlrev_b32 v113, 1, v113
    v_add_u32 v113, 113920, v113
    ds_write_b16 v113, v116
    s_mov_b64 exec, -1
    global_load_dword v254, v1, s[90:91] offset:2560
    s_waitcnt vmcnt(50)
    global_load_dword v251, v1, s[90:91] offset:3072
    global_load_dword v255, v1, s[90:91] offset:3584
    s_mov_b64 exec, -1
    s_cmp_eq_u32 s80, 0
    s_cbranch_scc1 L_noscat
    v_bfe_u32 v104, v12, 14, 6
    v_lshlrev_b32 v108, 2, v104
    ds_bpermute_b32 v108, v108, v153
    v_bfe_u32 v105, v13, 14, 6
    v_lshlrev_b32 v109, 2, v105
    ds_bpermute_b32 v109, v109, v153
    v_bfe_u32 v106, v14, 14, 6
    v_lshlrev_b32 v110, 2, v106
    ds_bpermute_b32 v110, v110, v153
    v_bfe_u32 v107, v15, 14, 6
    v_lshlrev_b32 v111, 2, v107
    ds_bpermute_b32 v111, v111, v153
    s_mov_b32 s83, 0xd8d8d8d8
    v_mov_b32 v116, 0x2b80
    s_waitcnt lgkmcnt(0)
    v_cmpx_le_i32 vcc, 0, v12
    v_add_u32 v108, v108, v148
    v_lshlrev_b32 v112, 1, v108
    v_bfe_u32 v112, s83, v112, 2
    v_bfi_b32 v108, 3, v112, v108
    v_and_b32 v114, 0x3fff, v12
    v_lshrrev_b32 v115, 20, v12
    v_add_u32 v115, v115, v152
    v_lshlrev_b32 v112, 3, v108
    v_add_u32 v112, 153872, v112
    ds_write_b64 v112, v[114:115]
    v_and_b32 v113, 31, v104
    v_mad_u32_u24 v113, v108, 24, v113
    v_lshlrev_b32 v113, 1, v113
    v_add_u32 v113, 113920, v113
    ds_write_b16 v113, v116
    v_cmpx_le_i32 vcc, 0, v13
    v_add_u32 v109, v109, v149
    v_lshlrev_b32 v112, 1, v109
    v_bfe_u32 v112, s83, v112, 2
    v_bfi_b32 v109, 3, v112, v109
    v_and_b32 v114, 0x3fff, v13
    v_lshrrev_b32 v115, 20, v13
    v_add_u32 v115, v115, v152
    v_lshlrev_b32 v112, 3, v109
    v_add_u32 v112, 153872, v112
    ds_write_b64 v112, v[114:115]
    v_and_b32 v113, 31, v105
    v_mad_u32_u24 v113, v109, 24, v113
    v_lshlrev_b32 v113, 1, v113
    v_add_u32 v113, 113920, v113
    ds_write_b16 v113, v116
    v_cmpx_le_i32 vcc, 0, v14
    v_add_u32 v110, v110, v150
    v_lshlrev_b32 v112, 1, v110
    v_bfe_u32 v112, s83, v112, 2
    v_bfi_b32 v110, 3, v112, v110
    v_and_b32 v114, 0x3fff, v14
    v_lshrrev_b32 v115, 20, v14
    v_add_u32 v115, v115, v152
    v_lshlrev_b32 v112, 3, v110
    v_add_u32 v112, 153872, v112
    ds_write_b64 v112, v[114:115]
    v_and_b32 v113, 31, v106
    v_mad_u32_u24 v113, v110, 24, v113
    v_lshlrev_b32 v113, 1, v113
    v_add_u32 v113, 113920, v113
    ds_write_b16 v113, v116
    v_cmpx_le_i32 vcc, 0, v15
    v_add_u32 v111, v111, v151
    v_lshlrev_b32 v112, 1, v111
    v_bfe_u32 v112, s83, v112, 2
    v_bfi_b32 v111, 3, v112, v111
    v_and_b32 v114, 0x3fff, v15
    v_lshrrev_b32 v115, 20, v15
    v_add_u32 v115, v115, v152
    v_lshlrev_b32 v112, 3, v111
    v_add_u32 v112, 153872, v112
    ds_write_b64 v112, v[114:115]
    v_and_b32 v113, 31, v107
    v_mad_u32_u24 v113, v111, 24, v113
    v_lshlrev_b32 v113, 1, v113
    v_add_u32 v113, 113920, v113
    ds_write_b16 v113, v116
    s_mov_b64 exec, -1
L_noscat:
    s_mul_i32 s71, s70, 416
    v_bfe_u32 v6, v0, 3, 3
    v_add_u32 v6, s71, v6
    v_lshlrev_b32 v158, 3, v6
    v_add_u32 v158, 153872, v158
    v_and_b32 v6, 31, v0
    v_add_u32 v6, s71, v6
    v_bfe_u32 v7, v0, 5, 1
    v_mul_u32_u24 v160, 48, v6
    v_lshl_add_u32 v160, v7, 4, v160
    v_add_u32 v160, 113920, v160
    v_bfe_u32 v159, v0, 3, 1
    v_xor_b32 v159, v159, v7
    v_lshlrev_b32 v159, 4, v159
    v_and_b32 v6, 31, v0
    v_lshl_add_u32 v159, v6, 5, v159
    s_lshl_b32 s40, s68, 11
    s_add_u32 s40, s40, 91648
    v_add_u32 v159, s40, v159
    v_bfe_u32 v3, v0, 1, 5
    v_add_u32 v3, s71, v3
    v_lshlrev_b32 v3, 3, v3
    v_add_u32 v3, 153876, v3
    v_lshrrev_b32 v5, 4, v0
    v_xor_b32 v5, v5, v0
    v_and_b32 v5, 1, v5
    v_lshlrev_b32 v5, 4, v5
    v_bfe_u32 v6, v0, 2, 1
    v_lshl_add_u32 v6, v7, 2, v6
    v_and_b32 v7, 8, v0
    v_add3_u32 v6, v6, v7, s71
    v_mul_u32_u24 v161, 48, v6
    v_and_b32 v6, 3, v0
    v_lshl_add_u32 v161, v6, 3, v161
    v_and_b32 v6, 16, v0
    v_lshl_add_u32 v161, v6, 1, v161
    v_add_u32 v161, 113920, v161
    v_bfe_u32 v6, v0, 4, 1
    v_lshlrev_b32 v6, 2, v6
    v_and_b32 v7, 7, v0
    v_xor_b32 v6, v6, v7
    v_lshlrev_b32 v151, 4, v6
    v_lshlrev_b32 v153, 4, v6
    v_lshlrev_b32 v155, 4, v6
    v_lshlrev_b32 v157, 4, v6
    s_waitcnt vmcnt(18)
    s_mov_b32 s71, 0
    s_mov_b32 exec_hi, 0
L_pverify:
    v_xor_b32 v6, s3, v64
    v_bitop3_b32 v6, v6, v65, s3 bitop3:0xf6
    v_bitop3_b32 v6, v6, v66, s3 bitop3:0xf6
    v_bitop3_b32 v6, v6, v67, s3 bitop3:0xf6
    v_cmp_ne_u32 vcc, 0, v6
    s_add_u32 s71, s71, 1
    s_cmp_gt_u32 s71, 0x20000
    s_cbranch_scc1 L_pok
    s_cbranch_vccz L_pok
    s_mov_b64 exec, vcc
    buffer_load_dwordx4 v[64:67], v63, s[52:55], 0 offen sc1
    s_waitcnt vmcnt(0)
    s_branch L_pverify
L_pok:
    s_mov_b64 exec, -1
    s_waitcnt lgkmcnt(0)
    s_barrier
    ds_read_b32 v150, v158 offset:0
    ds_read_b32 v152, v158 offset:64
    ds_read_b32 v154, v158 offset:128
    ds_read_b32 v156, v158 offset:192
    ds_read_b32 v4, v3 offset:0
    s_cmp_eq_u32 s41, 0
    s_cbranch_scc1 L_noqb
    buffer_load_dwordx4 v[24:27], v60, s[44:47], 0 offen offset:0 sc1
    buffer_load_dwordx4 v[28:31], v60, s[44:47], 0 offen offset:1024 sc1
    buffer_load_dwordx4 v[32:35], v60, s[44:47], 0 offen offset:2048 sc1
    buffer_load_dword v62, v61, s[44:47], 0 offen offset:3072 sc1
L_noqb:
    s_waitcnt lgkmcnt(0)
    s_add_u32 m0, s79, 0
    s_nop 0
    buffer_load_dwordx4 v[150:151], s[60:63], s78 idxen offen sc1 lds
    s_add_u32 m0, s79, 1024
    s_nop 0
    buffer_load_dwordx4 v[152:153], s[60:63], s78 idxen offen sc1 lds
    s_add_u32 m0, s79, 2048
    s_nop 0
    buffer_load_dwordx4 v[154:155], s[60:63], s78 idxen offen sc1 lds
    s_add_u32 m0, s79, 3072
    s_nop 0
    buffer_load_dwordx4 v[156:157], s[60:63], s78 idxen offen sc1 lds
    s_add_u32 m0, s40, 0
    s_nop 0
    buffer_load_dwordx4 v[4:5], s[28:31], 0 idxen offen lds
    ds_read_b32 v150, v158 offset:256
    ds_read_b32 v152, v158 offset:320
    ds_read_b32 v154, v158 offset:384
    ds_read_b32 v156, v158 offset:448
    ds_read_b32 v4, v3 offset:256
    ds_read_b128 v[104:107], v2 offset:0
    ds_read_b128 v[108:111], v2 offset:8704
    ds_read_b128 v[112:115], v2 offset:17408
    v_perm_b32 v188, v196, v192, s76
    v_perm_b32 v196, v196, v192, s77
    v_perm_b32 v189, v197, v193, s76
    v_perm_b32 v197, v197, v193, s77
    v_perm_b32 v190, v198, v194, s76
    v_perm_b32 v198, v198, v194, s77
    v_perm_b32 v191, v199, v195, s76
    v_perm_b32 v199, v199, v195, s77
    s_waitcnt lgkmcnt(0)
    v_mfma_f32_16x16x32_bf16 v[164:167], v[188:191], v[104:107], 0
    ds_read_b128 v[116:119], v2 offset:64
    v_mfma_f32_16x16x32_bf16 v[172:175], v[188:191], v[108:111], 0
    ds_read_b128 v[120:123], v2 offset:8768
    v_perm_b32 v192, v204, v200, s76
    v_perm_b32 v204, v204, v200, s77
    v_mfma_f32_16x16x32_bf16 v[180:183], v[188:191], v[112:115], 0
    ds_read_b128 v[124:127], v2 offset:17472
    v_perm_b32 v193, v205, v201, s76
    v_perm_b32 v205, v205, v201, s77
    v_mfma_f32_16x16x32_bf16 v[168:171], v[196:199], v[104:107], 0
    v_perm_b32 v194, v206, v202, s76
    v_perm_b32 v206, v206, v202, s77
    v_mfma_f32_16x16x32_bf16 v[176:179], v[196:199], v[108:111], 0
    v_perm_b32 v195, v207, v203, s76
    v_perm_b32 v207, v207, v203, s77
    v_mfma_f32_16x16x32_bf16 v[184:187], v[196:199], v[112:115], 0
    s_waitcnt lgkmcnt(0)
    v_mfma_f32_16x16x32_bf16 v[164:167], v[192:195], v[116:119], v[164:167]
    ds_read_b128 v[104:107], v2 offset:128
    v_mfma_f32_16x16x32_bf16 v[172:175], v[192:195], v[120:123], v[172:175]
    ds_read_b128 v[108:111], v2 offset:8832
    v_perm_b32 v200, v212, v208, s76
    v_perm_b32 v212, v212, v208, s77
    v_mfma_f32_16x16x32_bf16 v[180:183], v[192:195], v[124:127], v[180:183]
    ds_read_b128 v[112:115], v2 offset:17536
    v_perm_b32 v201, v213, v209, s76
    v_perm_b32 v213, v213, v209, s77
    v_mfma_f32_16x16x32_bf16 v[168:171], v[204:207], v[116:119], v[168:171]
    v_perm_b32 v202, v214, v210, s76
    v_perm_b32 v214, v214, v210, s77
    v_mfma_f32_16x16x32_bf16 v[176:179], v[204:207], v[120:123], v[176:179]
    v_perm_b32 v203, v215, v211, s76
    v_perm_b32 v215, v215, v211, s77
    v_mfma_f32_16x16x32_bf16 v[184:187], v[204:207], v[124:127], v[184:187]
    s_waitcnt lgkmcnt(0)
    v_mfma_f32_16x16x32_bf16 v[164:167], v[200:203], v[104:107], v[164:167]
    ds_read_b128 v[116:119], v2 offset:192
    v_mfma_f32_16x16x32_bf16 v[172:175], v[200:203], v[108:111], v[172:175]
    ds_read_b128 v[120:123], v2 offset:8896
    v_perm_b32 v208, v220, v216, s76
    v_perm_b32 v220, v220, v216, s77
    v_mfma_f32_16x16x32_bf16 v[180:183], v[200:203], v[112:115], v[180:183]
    ds_read_b128 v[124:127], v2 offset:17600
    v_perm_b32 v209, v221, v217, s76
    v_perm_b32 v221, v221, v217, s77
    v_mfma_f32_16x16x32_bf16 v[168:171], v[212:215], v[104:107], v[168:171]
    v_perm_b32 v210, v222, v218, s76
    v_perm_b32 v222, v222, v218, s77
    v_mfma_f32_16x16x32_bf16 v[176:179], v[212:215], v[108:111], v[176:179]
    v_perm_b32 v211, v223, v219, s76
    v_perm_b32 v223, v223, v219, s77
    v_mfma_f32_16x16x32_bf16 v[184:187], v[212:215], v[112:115], v[184:187]
    s_waitcnt lgkmcnt(0)
    v_mfma_f32_16x16x32_bf16 v[164:167], v[208:211], v[116:119], v[164:167]
    ds_read_b128 v[104:107], v2 offset:256
    v_mfma_f32_16x16x32_bf16 v[172:175], v[208:211], v[120:123], v[172:175]
    ds_read_b128 v[108:111], v2 offset:8960
    v_perm_b32 v216, v228, v224, s76
    v_perm_b32 v228, v228, v224, s77
    v_mfma_f32_16x16x32_bf16 v[180:183], v[208:211], v[124:127], v[180:183]
    ds_read_b128 v[112:115], v2 offset:17664
    v_perm_b32 v217, v229, v225, s76
    v_perm_b32 v229, v229, v225, s77
    v_mfma_f32_16x16x32_bf16 v[168:171], v[220:223], v[116:119], v[168:171]
    v_perm_b32 v218, v230, v226, s76
    v_perm_b32 v230, v230, v226, s77
    v_mfma_f32_16x16x32_bf16 v[176:179], v[220:223], v[120:123], v[176:179]
    v_perm_b32 v219, v231, v227, s76
    v_perm_b32 v231, v231, v227, s77
    v_mfma_f32_16x16x32_bf16 v[184:187], v[220:223], v[124:127], v[184:187]
    s_waitcnt lgkmcnt(0)
    v_mfma_f32_16x16x32_bf16 v[164:167], v[216:219], v[104:107], v[164:167]
    ds_read_b128 v[116:119], v2 offset:320
    v_mfma_f32_16x16x32_bf16 v[172:175], v[216:219], v[108:111], v[172:175]
    ds_read_b128 v[120:123], v2 offset:9024
    s_waitcnt vmcnt(21)
    v_perm_b32 v224, v236, v232, s76
    v_perm_b32 v236, v236, v232, s77
    v_mfma_f32_16x16x32_bf16 v[180:183], v[216:219], v[112:115], v[180:183]
    ds_read_b128 v[124:127], v2 offset:17728
    v_perm_b32 v225, v237, v233, s76
    v_perm_b32 v237, v237, v233, s77
    v_mfma_f32_16x16x32_bf16 v[168:171], v[228:231], v[104:107], v[168:171]
    v_perm_b32 v226, v238, v234, s76
    v_perm_b32 v238, v238, v234, s77
    v_mfma_f32_16x16x32_bf16 v[176:179], v[228:231], v[108:111], v[176:179]
    v_perm_b32 v227, v239, v235, s76
    v_perm_b32 v239, v239, v235, s77
    v_mfma_f32_16x16x32_bf16 v[184:187], v[228:231], v[112:115], v[184:187]
    s_waitcnt lgkmcnt(0)
    v_mfma_f32_16x16x32_bf16 v[164:167], v[224:227], v[116:119], v[164:167]
    ds_read_b128 v[104:107], v2 offset:384
    v_mfma_f32_16x16x32_bf16 v[172:175], v[224:227], v[120:123], v[172:175]
    ds_read_b128 v[108:111], v2 offset:9088
    s_waitcnt vmcnt(13)
    v_perm_b32 v232, v244, v240, s76
    v_perm_b32 v244, v244, v240, s77
    v_mfma_f32_16x16x32_bf16 v[180:183], v[224:227], v[124:127], v[180:183]
    ds_read_b128 v[112:115], v2 offset:17792
    v_perm_b32 v233, v245, v241, s76
    v_perm_b32 v245, v245, v241, s77
    v_mfma_f32_16x16x32_bf16 v[168:171], v[236:239], v[116:119], v[168:171]
    v_perm_b32 v234, v246, v242, s76
    v_perm_b32 v246, v246, v242, s77
    v_mfma_f32_16x16x32_bf16 v[176:179], v[236:239], v[120:123], v[176:179]
    v_perm_b32 v235, v247, v243, s76
    v_perm_b32 v247, v247, v243, s77
    v_mfma_f32_16x16x32_bf16 v[184:187], v[236:239], v[124:127], v[184:187]
    s_waitcnt lgkmcnt(0)
    v_mfma_f32_16x16x32_bf16 v[164:167], v[232:235], v[104:107], v[164:167]
    ds_read_b128 v[116:119], v2 offset:448
    v_mfma_f32_16x16x32_bf16 v[172:175], v[232:235], v[108:111], v[172:175]
    ds_read_b128 v[120:123], v2 offset:9152
    s_waitcnt vmcnt(5)
    v_perm_b32 v240, v252, v248, s76
    v_perm_b32 v252, v252, v248, s77
    v_mfma_f32_16x16x32_bf16 v[180:183], v[232:235], v[112:115], v[180:183]
    ds_read_b128 v[124:127], v2 offset:17856
    v_perm_b32 v241, v253, v249, s76
    v_perm_b32 v253, v253, v249, s77
    v_mfma_f32_16x16x32_bf16 v[168:171], v[244:247], v[104:107], v[168:171]
    v_perm_b32 v242, v254, v250, s76
    v_perm_b32 v254, v254, v250, s77
    v_mfma_f32_16x16x32_bf16 v[176:179], v[244:247], v[108:111], v[176:179]
    v_perm_b32 v243, v255, v251, s76
    v_perm_b32 v255, v255, v251, s77
    v_mfma_f32_16x16x32_bf16 v[184:187], v[244:247], v[112:115], v[184:187]
    s_waitcnt lgkmcnt(0)
    v_mfma_f32_16x16x32_bf16 v[164:167], v[240:243], v[116:119], v[164:167]
    v_mfma_f32_16x16x32_bf16 v[172:175], v[240:243], v[120:123], v[172:175]
    v_mfma_f32_16x16x32_bf16 v[180:183], v[240:243], v[124:127], v[180:183]
    v_mfma_f32_16x16x32_bf16 v[168:171], v[252:255], v[116:119], v[168:171]
    v_mfma_f32_16x16x32_bf16 v[176:179], v[252:255], v[120:123], v[176:179]
    v_mfma_f32_16x16x32_bf16 v[184:187], v[252:255], v[124:127], v[184:187]
    s_nop 7
    s_waitcnt lgkmcnt(0)
    s_add_u32 m0, s79, 32768
    s_nop 0
    buffer_load_dwordx4 v[150:151], s[60:63], s78 idxen offen sc1 lds
    s_add_u32 m0, s79, 33792
    s_nop 0
    buffer_load_dwordx4 v[152:153], s[60:63], s78 idxen offen sc1 lds
    s_add_u32 m0, s79, 34816
    s_nop 0
    buffer_load_dwordx4 v[154:155], s[60:63], s78 idxen offen sc1 lds
    s_add_u32 m0, s79, 35840
    s_nop 0
    buffer_load_dwordx4 v[156:157], s[60:63], s78 idxen offen sc1 lds
    s_add_u32 m0, s40, 1024
    s_nop 0
    buffer_load_dwordx4 v[4:5], s[28:31], 0 idxen offen lds
L_as2:
    s_add_u32 s71, s2, s68
    s_cmp_lg_u32 s71, 0
    s_cbranch_scc1 L_noep
    v_mov_b32 v6, 0x8000
    v_mov_b32 v7, s3
    s_mov_b64 exec, 1
    buffer_store_dword v7, v6, s[52:55], 0 offen
    s_mov_b64 exec, -1
L_noep:
    v_pk_mul_f32 v[164:165], v[164:165], s[86:87]
    v_pk_mul_f32 v[166:167], v[166:167], s[86:87]
    v_pk_mul_f32 v[168:169], v[168:169], s[86:87]
    v_pk_mul_f32 v[170:171], v[170:171], s[86:87]
    v_pk_mul_f32 v[172:173], v[172:173], s[86:87]
    v_pk_mul_f32 v[174:175], v[174:175], s[86:87]
    v_pk_mul_f32 v[176:177], v[176:177], s[86:87]
    v_pk_mul_f32 v[178:179], v[178:179], s[86:87]
    v_pk_mul_f32 v[180:181], v[180:181], s[86:87]
    v_pk_mul_f32 v[182:183], v[182:183], s[86:87]
    v_pk_mul_f32 v[184:185], v[184:185], s[86:87]
    v_pk_mul_f32 v[186:187], v[186:187], s[86:87]
    v_and_b32 v1, 63, v0
    v_lshlrev_b32 v1, 4, v1
    v_lshl_add_u32 v1, s68, 14, v1
    v_bfe_u32 v6, v0, 5, 1
    v_and_b32 v7, 31, v0
    v_lshlrev_b32 v6, 3, v6
    v_sub_u32 v6, v7, v6
    v_and_b32 v7, 1, v0
    v_lshlrev_b32 v7, 4, v7
    v_mov_b32 v134, 0x3f80
    v_lshlrev_b32 v7, v7, v134
    v_ashrrev_i32 v6, 1, v6
    v_cmp_eq_u32 vcc, 0, v6
    s_nop 1
    v_cndmask_b32 v8, 0, v7, vcc
    v_cmp_eq_u32 vcc, 1, v6
    s_nop 1
    v_cndmask_b32 v9, 0, v7, vcc
    v_cmp_eq_u32 vcc, 2, v6
    s_nop 1
    v_cndmask_b32 v10, 0, v7, vcc
    v_cmp_eq_u32 vcc, 3, v6
    s_nop 1
    v_cndmask_b32 v11, 0, v7, vcc
    v_cmp_eq_u32 vcc, 8, v6
    s_nop 1
    v_cndmask_b32 v12, 0, v7, vcc
    v_cmp_eq_u32 vcc, 9, v6
    s_nop 1
    v_cndmask_b32 v13, 0, v7, vcc
    v_cmp_eq_u32 vcc, 10, v6
    s_nop 1
    v_cndmask_b32 v14, 0, v7, vcc
    v_cmp_eq_u32 vcc, 11, v6
    s_nop 1
    v_cndmask_b32 v15, 0, v7, vcc
    s_waitcnt vmcnt(10)
    s_cmp_eq_u32 s41, 0
    s_cbranch_scc1 L_qok
    s_mov_b32 s71, 0
L_qverify:
    s_mul_i32 s72, s3, 3
    v_xor_b32 v24, s72, v24
    s_mul_i32 s72, s3, 5
    v_xor_b32 v28, s72, v28
    s_mul_i32 s72, s3, 7
    v_xor_b32 v32, s72, v32
    v_xor_b32 v6, s3, v24
    v_bitop3_b32 v6, v6, v25, v26 bitop3:0x96
    v_bitop3_b32 v6, v6, v27, v28 bitop3:0x96
    v_bitop3_b32 v6, v6, v29, v30 bitop3:0x96
    v_bitop3_b32 v6, v6, v31, v32 bitop3:0x96
    v_bitop3_b32 v6, v6, v33, v34 bitop3:0x96
    v_xor_b32 v6, v6, v35
    v_cmp_ne_u32 vcc, v6, v62
    s_add_u32 s71, s71, 1
    s_cmp_gt_u32 s71, 0x20000
    s_cbranch_scc1 L_qok
    s_cbranch_vccz L_qok
    s_mov_b64 exec, vcc
    buffer_load_dwordx4 v[24:27], v60, s[44:47], 0 offen offset:0 sc1
    buffer_load_dwordx4 v[28:31], v60, s[44:47], 0 offen offset:1024 sc1
    buffer_load_dwordx4 v[32:35], v60, s[44:47], 0 offen offset:2048 sc1
    buffer_load_dword v62, v61, s[44:47], 0 offen offset:3072 sc1
    s_waitcnt vmcnt(0)
    s_branch L_qverify
L_qok:
    s_mov_b64 exec, -1
    v_mov_b32 v36, 0
    v_mov_b32 v37, 0
    v_mov_b32 v38, 0
    v_mov_b32 v39, 0
    v_mov_b32 v40, 0
    v_mov_b32 v41, 0
    v_mov_b32 v42, 0
    v_mov_b32 v43, 0
    v_mov_b32 v44, 0
    v_mov_b32 v45, 0
    v_mov_b32 v46, 0
    v_mov_b32 v47, 0
    v_mov_b32 v48, 0
    v_mov_b32 v49, 0
    v_mov_b32 v50, 0
    v_mov_b32 v51, 0
    v_mov_b32 v52, 0
    v_mov_b32 v53, 0
    v_mov_b32 v54, 0
    v_mov_b32 v55, 0
    v_mov_b32 v56, 0
    v_mov_b32 v57, 0
    v_mov_b32 v58, 0
    v_mov_b32 v59, 0
    v_mov_b32 v60, 0
    v_mov_b32 v61, 0
    v_mov_b32 v62, 0
    v_mov_b32 v63, 0
    v_mov_b32 v64, 0
    v_mov_b32 v65, 0
    v_mov_b32 v66, 0
    v_mov_b32 v67, 0
    s_waitcnt vmcnt(5)
    s_mov_b32 exec_lo, 0
    v_mov_b32 v32, 0
    v_mov_b32 v33, 0
    v_mov_b32 v34, 0
    v_mov_b32 v35, 0
    s_mov_b32 exec_lo, -1
    s_cmp_lg_u32 s81, 0
    s_cbranch_scc1 L_slow_first
L_run:
    s_cmp_eq_u32 s70, 0
    s_cbranch_scc1 L_pr
    s_setprio 1
L_pr:
    s_mov_b32 s41, 3
    s_cmp_eq_u32 s74, 0
    s_cbranch_scc1 L_loop_done
    ds_read_b64_tr_b16 v[100:101], v162 offset:0
    ds_read_b64_tr_b16 v[102:103], v162 offset:512
    ds_read_b64_tr_b16 v[104:105], v162 offset:2048
    ds_read_b64_tr_b16 v[106:107], v162 offset:2560
    ds_read_b64_tr_b16 v[108:109], v163 offset:0
    ds_read_b64_tr_b16 v[110:111], v163 offset:512
    ds_read_b64_tr_b16 v[112:113], v163 offset:2048
    ds_read_b64_tr_b16 v[114:115], v163 offset:2560
    ds_read_b128 v[116:119], v159 offset:0
    ds_read_b128 v[120:123], v160 offset:0
    ds_read_b64 v[124:125], v160 offset:32
    ds_read_b32 v150, v158 offset:512
    ds_read_b32 v152, v158 offset:576
    ds_read_b32 v154, v158 offset:640
    ds_read_b32 v156, v158 offset:704
    ds_read_b32 v4, v3 offset:512
    v_mov_b32 v126, 0
    v_mov_b32 v130, 0
    v_mov_b32 v127, 0
    v_mov_b32 v131, 0
    v_mov_b32 v128, 0
    v_mov_b32 v132, 0
    v_mov_b32 v129, 0
    v_mov_b32 v133, 0
    s_waitcnt lgkmcnt(0)
    v_mfma_f32_32x32x16_bf16 v[68:83], v[8:11], v[100:103], 0
    v_mfma_f32_32x32x16_bf16 v[68:83], v[12:15], v[104:107], v[68:83]
    v_mfma_f32_32x32x16_bf16 v[68:83], v[116:119], v[16:19], v[68:83]
    v_mfma_f32_32x32x16_bf16 v[68:83], v[120:123], v[24:27], v[68:83]
    v_mfma_f32_32x32x8_bf16 v[68:83], v[124:125], v[32:33], v[68:83]
    s_add_u32 m0, s79, 0
    s_nop 0
    buffer_load_dwordx4 v[150:151], s[60:63], s78 idxen offen sc1 lds
    s_add_u32 m0, s79, 1024
    s_nop 0
    buffer_load_dwordx4 v[152:153], s[60:63], s78 idxen offen sc1 lds
    s_add_u32 m0, s79, 2048
    s_nop 0
    buffer_load_dwordx4 v[154:155], s[60:63], s78 idxen offen sc1 lds
    s_add_u32 m0, s79, 3072
    s_nop 0
    buffer_load_dwordx4 v[156:157], s[60:63], s78 idxen offen sc1 lds
    s_add_u32 m0, s40, 0
    s_nop 0
    buffer_load_dwordx4 v[4:5], s[28:31], 0 idxen offen lds
    s_sub_u32 s75, s74, 1
    s_nop 3
    s_cmp_eq_u32 s75, 0
    s_cbranch_scc1 L_loop_exit
    s_cmp_lt_u32 s42, 224
    s_cbranch_scc1 L_loop
    .p2align 3
L_loopa:
    s_waitcnt vmcnt(5)
    v_mfma_f32_32x32x16_bf16 v[84:99], v[8:11], v[108:111], 0
    v_exp_f32 v134, v68
    ds_read_b64_tr_b16 v[100:101], v162 offset:32768
    v_exp_f32 v135, v69
    ds_read_b64_tr_b16 v[102:103], v162 offset:33280
    v_exp_f32 v136, v70
    ds_read_b64_tr_b16 v[104:105], v162 offset:34816
    v_mfma_f32_32x32x16_bf16 v[84:99], v[12:15], v[112:115], v[84:99]
    v_exp_f32 v137, v71
    ds_read_b64_tr_b16 v[106:107], v162 offset:35328
    v_exp_f32 v138, v72
    ds_read_b64_tr_b16 v[108:109], v163 offset:32768
    v_exp_f32 v139, v73
    ds_read_b64_tr_b16 v[110:111], v163 offset:33280
    v_mfma_f32_32x32x16_bf16 v[84:99], v[116:119], v[20:23], v[84:99]
    v_exp_f32 v140, v74
    ds_read_b64_tr_b16 v[112:113], v163 offset:34816
    v_exp_f32 v141, v75
    ds_read_b64_tr_b16 v[114:115], v163 offset:35328
    v_exp_f32 v142, v76
    ds_read_b128 v[116:119], v159 offset:1024
    v_mfma_f32_32x32x16_bf16 v[84:99], v[120:123], v[28:31], v[84:99]
    v_exp_f32 v143, v77
    ds_read_b32 v150, v158 offset:768
    v_exp_f32 v144, v78
    ds_read_b32 v152, v158 offset:832
    v_exp_f32 v145, v79
    ds_read_b128 v[120:123], v160 offset:1536
    v_exp_f32 v146, v80
    ds_read_b32 v154, v158 offset:896
    v_exp_f32 v147, v81
    ds_read_b32 v156, v158 offset:960
    v_exp_f32 v148, v82
    v_exp_f32 v149, v83
    ds_read_b32 v4, v3 offset:768
    v_pk_fma_f32 v[134:135], v[134:135], s[84:85], s[84:85] clamp
    v_pk_fma_f32 v[136:137], v[136:137], s[84:85], s[84:85] clamp
    v_pk_fma_f32 v[138:139], v[138:139], s[84:85], s[84:85] clamp
    v_pk_fma_f32 v[140:141], v[140:141], s[84:85], s[84:85] clamp
    v_pk_fma_f32 v[142:143], v[142:143], s[84:85], s[84:85] clamp
    v_pk_fma_f32 v[144:145], v[144:145], s[84:85], s[84:85] clamp
    v_pk_fma_f32 v[146:147], v[146:147], s[84:85], s[84:85] clamp
    v_pk_fma_f32 v[148:149], v[148:149], s[84:85], s[84:85] clamp
    v_pk_mul_f32 v[68:69], v[68:69], v[136:137]
    v_pk_mul_f32 v[72:73], v[72:73], v[140:141]
    v_pk_mul_f32 v[76:77], v[76:77], v[144:145]
    v_pk_mul_f32 v[80:81], v[80:81], v[148:149]
    v_pk_fma_f32 v[68:69], v[70:71], v[134:135], v[68:69]
    v_pk_fma_f32 v[72:73], v[74:75], v[138:139], v[72:73]
    v_pk_fma_f32 v[76:77], v[78:79], v[142:143], v[76:77]
    v_pk_fma_f32 v[80:81], v[82:83], v[146:147], v[80:81]
    v_pk_mul_f32 v[134:135], v[134:135], v[136:137]
    v_pk_mul_f32 v[138:139], v[138:139], v[140:141]
    v_pk_mul_f32 v[142:143], v[142:143], v[144:145]
    v_pk_mul_f32 v[146:147], v[146:147], v[148:149]
    s_waitcnt lgkmcnt(0)
    v_mfma_f32_32x32x16_bf16 v[52:67], v[130:133], v[126:129], v[52:67]
    v_rcp_f32 v134, v134
    v_rcp_f32 v135, v135
    s_add_u32 m0, s79, 32768
    v_rcp_f32 v138, v138
    buffer_load_dwordx4 v[150:151], s[60:63], s78 idxen offen sc1 lds
    v_rcp_f32 v139, v139
    ds_read_b64_tr_b16 v[126:127], v161 offset:0
    v_rcp_f32 v142, v142
    v_rcp_f32 v143, v143
    v_rcp_f32 v146, v146
    v_rcp_f32 v147, v147
    ds_read_b64_tr_b16 v[128:129], v161 offset:768
    v_pk_mul_f32 v[68:69], v[68:69], v[134:135]
    v_pk_mul_f32 v[72:73], v[72:73], v[138:139]
    v_pk_mul_f32 v[76:77], v[76:77], v[142:143]
    v_pk_mul_f32 v[80:81], v[80:81], v[146:147]
    v_cvt_pk_bf16_f32 v130, v68, v69
    v_cvt_pk_bf16_f32 v131, v72, v73
    v_cvt_pk_bf16_f32 v132, v76, v77
    v_cvt_pk_bf16_f32 v133, v80, v81
    v_mfma_f32_32x32x16_bf16 v[68:83], v[8:11], v[100:103], 0
    v_exp_f32 v134, v84
    s_add_u32 m0, s79, 33792
    v_exp_f32 v135, v85
    buffer_load_dwordx4 v[152:153], s[60:63], s78 idxen offen sc1 lds
    v_exp_f32 v136, v86
    v_mfma_f32_32x32x16_bf16 v[68:83], v[12:15], v[104:107], v[68:83]
    v_exp_f32 v137, v87
    v_exp_f32 v138, v88
    v_exp_f32 v139, v89
    v_mfma_f32_32x32x16_bf16 v[68:83], v[116:119], v[16:19], v[68:83]
    v_exp_f32 v140, v90
    s_add_u32 m0, s79, 34816
    v_exp_f32 v141, v91
    buffer_load_dwordx4 v[154:155], s[60:63], s78 idxen offen sc1 lds
    v_exp_f32 v142, v92
    v_mfma_f32_32x32x16_bf16 v[68:83], v[120:123], v[24:27], v[68:83]
    v_exp_f32 v143, v93
    v_exp_f32 v144, v94
    v_exp_f32 v145, v95
    v_exp_f32 v146, v96
    s_add_u32 m0, s79, 35840
    v_exp_f32 v147, v97
    buffer_load_dwordx4 v[156:157], s[60:63], s78 idxen offen sc1 lds
    v_exp_f32 v148, v98
    v_exp_f32 v149, v99
    v_pk_fma_f32 v[134:135], v[134:135], s[84:85], s[84:85] clamp
    v_pk_fma_f32 v[136:137], v[136:137], s[84:85], s[84:85] clamp
    v_pk_fma_f32 v[138:139], v[138:139], s[84:85], s[84:85] clamp
    v_pk_fma_f32 v[140:141], v[140:141], s[84:85], s[84:85] clamp
    v_pk_fma_f32 v[142:143], v[142:143], s[84:85], s[84:85] clamp
    v_pk_fma_f32 v[144:145], v[144:145], s[84:85], s[84:85] clamp
    v_pk_fma_f32 v[146:147], v[146:147], s[84:85], s[84:85] clamp
    v_pk_fma_f32 v[148:149], v[148:149], s[84:85], s[84:85] clamp
    v_pk_mul_f32 v[84:85], v[84:85], v[136:137]
    v_pk_mul_f32 v[88:89], v[88:89], v[140:141]
    v_pk_mul_f32 v[92:93], v[92:93], v[144:145]
    v_pk_mul_f32 v[96:97], v[96:97], v[148:149]
    v_pk_fma_f32 v[84:85], v[86:87], v[134:135], v[84:85]
    v_pk_fma_f32 v[88:89], v[90:91], v[138:139], v[88:89]
    v_pk_fma_f32 v[92:93], v[94:95], v[142:143], v[92:93]
    v_pk_fma_f32 v[96:97], v[98:99], v[146:147], v[96:97]
    v_pk_mul_f32 v[134:135], v[134:135], v[136:137]
    v_pk_mul_f32 v[138:139], v[138:139], v[140:141]
    v_pk_mul_f32 v[142:143], v[142:143], v[144:145]
    v_pk_mul_f32 v[146:147], v[146:147], v[148:149]
    s_waitcnt lgkmcnt(0)
    v_mfma_f32_32x32x16_bf16 v[36:51], v[130:133], v[126:129], v[36:51]
    v_rcp_f32 v134, v134
    v_rcp_f32 v135, v135
    s_add_u32 m0, s40, 1024
    v_rcp_f32 v138, v138
    buffer_load_dwordx4 v[4:5], s[28:31], 0 idxen offen lds
    v_rcp_f32 v139, v139
    v_rcp_f32 v142, v142
    v_rcp_f32 v143, v143
    v_rcp_f32 v146, v146
    v_rcp_f32 v147, v147
    v_pk_mul_f32 v[84:85], v[84:85], v[134:135]
    v_pk_mul_f32 v[88:89], v[88:89], v[138:139]
    v_pk_mul_f32 v[92:93], v[92:93], v[142:143]
    v_pk_mul_f32 v[96:97], v[96:97], v[146:147]
    v_cvt_pk_bf16_f32 v130, v84, v85
    v_cvt_pk_bf16_f32 v131, v88, v89
    v_cvt_pk_bf16_f32 v132, v92, v93
    v_cvt_pk_bf16_f32 v133, v96, v97
    s_sub_u32 s75, s75, 1
    s_waitcnt vmcnt(5)
    v_mfma_f32_32x32x16_bf16 v[84:99], v[8:11], v[108:111], 0
    v_exp_f32 v134, v68
    ds_read_b64_tr_b16 v[100:101], v162 offset:0
    v_exp_f32 v135, v69
    ds_read_b64_tr_b16 v[102:103], v162 offset:512
    v_exp_f32 v136, v70
    ds_read_b64_tr_b16 v[104:105], v162 offset:2048
    v_mfma_f32_32x32x16_bf16 v[84:99], v[12:15], v[112:115], v[84:99]
    v_exp_f32 v137, v71
    ds_read_b64_tr_b16 v[106:107], v162 offset:2560
    v_exp_f32 v138, v72
    ds_read_b64_tr_b16 v[108:109], v163 offset:0
    v_exp_f32 v139, v73
    ds_read_b64_tr_b16 v[110:111], v163 offset:512
    v_mfma_f32_32x32x16_bf16 v[84:99], v[116:119], v[20:23], v[84:99]
    v_exp_f32 v140, v74
    ds_read_b64_tr_b16 v[112:113], v163 offset:2048
    v_exp_f32 v141, v75
    ds_read_b64_tr_b16 v[114:115], v163 offset:2560
    v_exp_f32 v142, v76
    ds_read_b128 v[116:119], v159 offset:0
    v_mfma_f32_32x32x16_bf16 v[84:99], v[120:123], v[28:31], v[84:99]
    v_exp_f32 v143, v77
    ds_read_b32 v150, v158 offset:1024
    v_exp_f32 v144, v78
    ds_read_b32 v152, v158 offset:1088
    v_exp_f32 v145, v79
    ds_read_b128 v[120:123], v160 offset:3072
    v_exp_f32 v146, v80
    ds_read_b32 v154, v158 offset:1152
    v_exp_f32 v147, v81
    ds_read_b32 v156, v158 offset:1216
    v_exp_f32 v148, v82
    v_exp_f32 v149, v83
    ds_read_b32 v4, v3 offset:1024
    v_pk_fma_f32 v[134:135], v[134:135], s[84:85], s[84:85] clamp
    v_pk_fma_f32 v[136:137], v[136:137], s[84:85], s[84:85] clamp
    v_pk_fma_f32 v[138:139], v[138:139], s[84:85], s[84:85] clamp
    v_pk_fma_f32 v[140:141], v[140:141], s[84:85], s[84:85] clamp
    v_pk_fma_f32 v[142:143], v[142:143], s[84:85], s[84:85] clamp
    v_pk_fma_f32 v[144:145], v[144:145], s[84:85], s[84:85] clamp
    v_pk_fma_f32 v[146:147], v[146:147], s[84:85], s[84:85] clamp
    v_pk_fma_f32 v[148:149], v[148:149], s[84:85], s[84:85] clamp
    v_pk_mul_f32 v[68:69], v[68:69], v[136:137]
    v_pk_mul_f32 v[72:73], v[72:73], v[140:141]
    v_pk_mul_f32 v[76:77], v[76:77], v[144:145]
    v_pk_mul_f32 v[80:81], v[80:81], v[148:149]
    v_pk_fma_f32 v[68:69], v[70:71], v[134:135], v[68:69]
    v_pk_fma_f32 v[72:73], v[74:75], v[138:139], v[72:73]
    v_pk_fma_f32 v[76:77], v[78:79], v[142:143], v[76:77]
    v_pk_fma_f32 v[80:81], v[82:83], v[146:147], v[80:81]
    v_pk_mul_f32 v[134:135], v[134:135], v[136:137]
    v_pk_mul_f32 v[138:139], v[138:139], v[140:141]
    v_pk_mul_f32 v[142:143], v[142:143], v[144:145]
    v_pk_mul_f32 v[146:147], v[146:147], v[148:149]
    s_waitcnt lgkmcnt(0)
    v_mfma_f32_32x32x16_bf16 v[52:67], v[130:133], v[126:129], v[52:67]
    v_rcp_f32 v134, v134
    v_rcp_f32 v135, v135
    s_add_u32 m0, s79, 0
    v_rcp_f32 v138, v138
    buffer_load_dwordx4 v[150:151], s[60:63], s78 idxen offen sc1 lds
    v_rcp_f32 v139, v139
    ds_read_b64_tr_b16 v[126:127], v161 offset:1536
    v_rcp_f32 v142, v142
    v_rcp_f32 v143, v143
    v_rcp_f32 v146, v146
    v_rcp_f32 v147, v147
    ds_read_b64_tr_b16 v[128:129], v161 offset:2304
    v_pk_mul_f32 v[68:69], v[68:69], v[134:135]
    v_pk_mul_f32 v[72:73], v[72:73], v[138:139]
    v_pk_mul_f32 v[76:77], v[76:77], v[142:143]
    v_pk_mul_f32 v[80:81], v[80:81], v[146:147]
    v_cvt_pk_bf16_f32 v130, v68, v69
    v_cvt_pk_bf16_f32 v131, v72, v73
    v_cvt_pk_bf16_f32 v132, v76, v77
    v_cvt_pk_bf16_f32 v133, v80, v81
    v_mfma_f32_32x32x16_bf16 v[68:83], v[8:11], v[100:103], 0
    v_exp_f32 v134, v84
    s_add_u32 m0, s79, 1024
    v_exp_f32 v135, v85
    buffer_load_dwordx4 v[152:153], s[60:63], s78 idxen offen sc1 lds
    v_exp_f32 v136, v86
    v_mfma_f32_32x32x16_bf16 v[68:83], v[12:15], v[104:107], v[68:83]
    v_exp_f32 v137, v87
    v_exp_f32 v138, v88
    v_exp_f32 v139, v89
    v_mfma_f32_32x32x16_bf16 v[68:83], v[116:119], v[16:19], v[68:83]
    v_exp_f32 v140, v90
    s_add_u32 m0, s79, 2048
    v_exp_f32 v141, v91
    buffer_load_dwordx4 v[154:155], s[60:63], s78 idxen offen sc1 lds
    v_exp_f32 v142, v92
    v_mfma_f32_32x32x16_bf16 v[68:83], v[120:123], v[24:27], v[68:83]
    v_exp_f32 v143, v93
    v_exp_f32 v144, v94
    v_exp_f32 v145, v95
    v_exp_f32 v146, v96
    s_add_u32 m0, s79, 3072
    v_exp_f32 v147, v97
    buffer_load_dwordx4 v[156:157], s[60:63], s78 idxen offen sc1 lds
    v_exp_f32 v148, v98
    v_exp_f32 v149, v99
    v_pk_fma_f32 v[134:135], v[134:135], s[84:85], s[84:85] clamp
    v_pk_fma_f32 v[136:137], v[136:137], s[84:85], s[84:85] clamp
    v_pk_fma_f32 v[138:139], v[138:139], s[84:85], s[84:85] clamp
    v_pk_fma_f32 v[140:141], v[140:141], s[84:85], s[84:85] clamp
    v_pk_fma_f32 v[142:143], v[142:143], s[84:85], s[84:85] clamp
    v_pk_fma_f32 v[144:145], v[144:145], s[84:85], s[84:85] clamp
    v_pk_fma_f32 v[146:147], v[146:147], s[84:85], s[84:85] clamp
    v_pk_fma_f32 v[148:149], v[148:149], s[84:85], s[84:85] clamp
    v_pk_mul_f32 v[84:85], v[84:85], v[136:137]
    v_pk_mul_f32 v[88:89], v[88:89], v[140:141]
    v_pk_mul_f32 v[92:93], v[92:93], v[144:145]
    v_pk_mul_f32 v[96:97], v[96:97], v[148:149]
    v_pk_fma_f32 v[84:85], v[86:87], v[134:135], v[84:85]
    v_pk_fma_f32 v[88:89], v[90:91], v[138:139], v[88:89]
    v_pk_fma_f32 v[92:93], v[94:95], v[142:143], v[92:93]
    v_pk_fma_f32 v[96:97], v[98:99], v[146:147], v[96:97]
    v_pk_mul_f32 v[134:135], v[134:135], v[136:137]
    v_pk_mul_f32 v[138:139], v[138:139], v[140:141]
    v_pk_mul_f32 v[142:143], v[142:143], v[144:145]
    v_pk_mul_f32 v[146:147], v[146:147], v[148:149]
    s_waitcnt lgkmcnt(0)
    v_mfma_f32_32x32x16_bf16 v[36:51], v[130:133], v[126:129], v[36:51]
    v_rcp_f32 v134, v134
    v_rcp_f32 v135, v135
    s_add_u32 m0, s40, 0
    v_rcp_f32 v138, v138
    buffer_load_dwordx4 v[4:5], s[28:31], 0 idxen offen lds
    v_rcp_f32 v139, v139
    v_rcp_f32 v142, v142
    v_rcp_f32 v143, v143
    v_rcp_f32 v146, v146
    v_rcp_f32 v147, v147
    v_pk_mul_f32 v[84:85], v[84:85], v[134:135]
    v_pk_mul_f32 v[88:89], v[88:89], v[138:139]
    v_pk_mul_f32 v[92:93], v[92:93], v[142:143]
    v_pk_mul_f32 v[96:97], v[96:97], v[146:147]
    v_cvt_pk_bf16_f32 v130, v84, v85
    v_cvt_pk_bf16_f32 v131, v88, v89
    v_cvt_pk_bf16_f32 v132, v92, v93
    v_cvt_pk_bf16_f32 v133, v96, v97
    v_add_u32 v158, 512, v158
    v_add_u32 v3, 512, v3
    v_add_u32 v160, 3072, v160
    v_add_u32 v161, 3072, v161
    s_sub_u32 s75, s75, 1
    s_sub_u32 s41, s41, 1
    s_cmp_lg_u32 s41, 0
    s_cbranch_scc1 L_loopa
    s_cmp_eq_u32 s75, 0
    s_cbranch_scc1 L_loop_exit
    s_branch L_wpair
    .p2align 3
L_loop:
    s_waitcnt vmcnt(5)
    v_mfma_f32_32x32x16_bf16 v[84:99], v[8:11], v[108:111], 0
    v_exp_f32 v134, v68
    ds_read_b64_tr_b16 v[100:101], v162 offset:32768
    v_exp_f32 v135, v69
    ds_read_b64_tr_b16 v[102:103], v162 offset:33280
    v_exp_f32 v136, v70
    ds_read_b64_tr_b16 v[104:105], v162 offset:34816
    v_mfma_f32_32x32x16_bf16 v[84:99], v[12:15], v[112:115], v[84:99]
    v_exp_f32 v137, v71
    ds_read_b64_tr_b16 v[106:107], v162 offset:35328
    v_exp_f32 v138, v72
    ds_read_b64_tr_b16 v[108:109], v163 offset:32768
    v_exp_f32 v139, v73
    ds_read_b64_tr_b16 v[110:111], v163 offset:33280
    v_mfma_f32_32x32x16_bf16 v[84:99], v[116:119], v[20:23], v[84:99]
    v_exp_f32 v140, v74
    ds_read_b64_tr_b16 v[112:113], v163 offset:34816
    v_exp_f32 v141, v75
    ds_read_b64_tr_b16 v[114:115], v163 offset:35328
    v_exp_f32 v142, v76
    ds_read_b128 v[116:119], v159 offset:1024
    v_mfma_f32_32x32x16_bf16 v[84:99], v[120:123], v[28:31], v[84:99]
    v_exp_f32 v143, v77
    ds_read_b32 v150, v158 offset:768
    v_exp_f32 v144, v78
    ds_read_b32 v152, v158 offset:832
    v_exp_f32 v145, v79
    ds_read_b128 v[120:123], v160 offset:1536
    v_mfma_f32_32x32x8_bf16 v[84:99], v[124:125], v[34:35], v[84:99]
    v_exp_f32 v146, v80
    ds_read_b32 v154, v158 offset:896
    v_exp_f32 v147, v81
    ds_read_b32 v156, v158 offset:960
    v_exp_f32 v148, v82
    ds_read_b64 v[124:125], v160 offset:1568
    v_exp_f32 v149, v83
    ds_read_b32 v4, v3 offset:768
    v_pk_fma_f32 v[134:135], v[134:135], s[84:85], s[84:85] clamp
    v_pk_fma_f32 v[136:137], v[136:137], s[84:85], s[84:85] clamp
    v_pk_fma_f32 v[138:139], v[138:139], s[84:85], s[84:85] clamp
    v_pk_fma_f32 v[140:141], v[140:141], s[84:85], s[84:85] clamp
    v_pk_fma_f32 v[142:143], v[142:143], s[84:85], s[84:85] clamp
    v_pk_fma_f32 v[144:145], v[144:145], s[84:85], s[84:85] clamp
    v_pk_fma_f32 v[146:147], v[146:147], s[84:85], s[84:85] clamp
    v_pk_fma_f32 v[148:149], v[148:149], s[84:85], s[84:85] clamp
    v_pk_mul_f32 v[68:69], v[68:69], v[136:137]
    v_pk_mul_f32 v[72:73], v[72:73], v[140:141]
    v_pk_mul_f32 v[76:77], v[76:77], v[144:145]
    v_pk_mul_f32 v[80:81], v[80:81], v[148:149]
    v_pk_fma_f32 v[68:69], v[70:71], v[134:135], v[68:69]
    v_pk_fma_f32 v[72:73], v[74:75], v[138:139], v[72:73]
    v_pk_fma_f32 v[76:77], v[78:79], v[142:143], v[76:77]
    v_pk_fma_f32 v[80:81], v[82:83], v[146:147], v[80:81]
    v_pk_mul_f32 v[134:135], v[134:135], v[136:137]
    v_pk_mul_f32 v[138:139], v[138:139], v[140:141]
    v_pk_mul_f32 v[142:143], v[142:143], v[144:145]
    v_pk_mul_f32 v[146:147], v[146:147], v[148:149]
    s_waitcnt lgkmcnt(0)
    v_mfma_f32_32x32x16_bf16 v[52:67], v[130:133], v[126:129], v[52:67]
    v_rcp_f32 v134, v134
    v_rcp_f32 v135, v135
    s_add_u32 m0, s79, 32768
    v_rcp_f32 v138, v138
    buffer_load_dwordx4 v[150:151], s[60:63], s78 idxen offen sc1 lds
    v_rcp_f32 v139, v139
    ds_read_b64_tr_b16 v[126:127], v161 offset:0
    v_rcp_f32 v142, v142
    v_rcp_f32 v143, v143
    v_rcp_f32 v146, v146
    v_rcp_f32 v147, v147
    ds_read_b64_tr_b16 v[128:129], v161 offset:768
    v_pk_mul_f32 v[68:69], v[68:69], v[134:135]
    v_pk_mul_f32 v[72:73], v[72:73], v[138:139]
    v_pk_mul_f32 v[76:77], v[76:77], v[142:143]
    v_pk_mul_f32 v[80:81], v[80:81], v[146:147]
    v_cvt_pk_bf16_f32 v130, v68, v69
    v_cvt_pk_bf16_f32 v131, v72, v73
    v_cvt_pk_bf16_f32 v132, v76, v77
    v_cvt_pk_bf16_f32 v133, v80, v81
    v_mfma_f32_32x32x16_bf16 v[68:83], v[8:11], v[100:103], 0
    v_exp_f32 v134, v84
    s_add_u32 m0, s79, 33792
    v_exp_f32 v135, v85
    buffer_load_dwordx4 v[152:153], s[60:63], s78 idxen offen sc1 lds
    v_exp_f32 v136, v86
    v_mfma_f32_32x32x16_bf16 v[68:83], v[12:15], v[104:107], v[68:83]
    v_exp_f32 v137, v87
    v_exp_f32 v138, v88
    v_exp_f32 v139, v89
    v_mfma_f32_32x32x16_bf16 v[68:83], v[116:119], v[16:19], v[68:83]
    v_exp_f32 v140, v90
    s_add_u32 m0, s79, 34816
    v_exp_f32 v141, v91
    buffer_load_dwordx4 v[154:155], s[60:63], s78 idxen offen sc1 lds
    v_exp_f32 v142, v92
    v_mfma_f32_32x32x16_bf16 v[68:83], v[120:123], v[24:27], v[68:83]
    v_exp_f32 v143, v93
    v_exp_f32 v144, v94
    v_exp_f32 v145, v95
    v_mfma_f32_32x32x8_bf16 v[68:83], v[124:125], v[32:33], v[68:83]
    v_exp_f32 v146, v96
    s_add_u32 m0, s79, 35840
    v_exp_f32 v147, v97
    buffer_load_dwordx4 v[156:157], s[60:63], s78 idxen offen sc1 lds
    v_exp_f32 v148, v98
    v_exp_f32 v149, v99
    v_pk_fma_f32 v[134:135], v[134:135], s[84:85], s[84:85] clamp
    v_pk_fma_f32 v[136:137], v[136:137], s[84:85], s[84:85] clamp
    v_pk_fma_f32 v[138:139], v[138:139], s[84:85], s[84:85] clamp
    v_pk_fma_f32 v[140:141], v[140:141], s[84:85], s[84:85] clamp
    v_pk_fma_f32 v[142:143], v[142:143], s[84:85], s[84:85] clamp
    v_pk_fma_f32 v[144:145], v[144:145], s[84:85], s[84:85] clamp
    v_pk_fma_f32 v[146:147], v[146:147], s[84:85], s[84:85] clamp
    v_pk_fma_f32 v[148:149], v[148:149], s[84:85], s[84:85] clamp
    v_pk_mul_f32 v[84:85], v[84:85], v[136:137]
    v_pk_mul_f32 v[88:89], v[88:89], v[140:141]
    v_pk_mul_f32 v[92:93], v[92:93], v[144:145]
    v_pk_mul_f32 v[96:97], v[96:97], v[148:149]
    v_pk_fma_f32 v[84:85], v[86:87], v[134:135], v[84:85]
    v_pk_fma_f32 v[88:89], v[90:91], v[138:139], v[88:89]
    v_pk_fma_f32 v[92:93], v[94:95], v[142:143], v[92:93]
    v_pk_fma_f32 v[96:97], v[98:99], v[146:147], v[96:97]
    v_pk_mul_f32 v[134:135], v[134:135], v[136:137]
    v_pk_mul_f32 v[138:139], v[138:139], v[140:141]
    v_pk_mul_f32 v[142:143], v[142:143], v[144:145]
    v_pk_mul_f32 v[146:147], v[146:147], v[148:149]
    s_waitcnt lgkmcnt(0)
    v_mfma_f32_32x32x16_bf16 v[36:51], v[130:133], v[126:129], v[36:51]
    v_rcp_f32 v134, v134
    v_rcp_f32 v135, v135
    s_add_u32 m0, s40, 1024
    v_rcp_f32 v138, v138
    buffer_load_dwordx4 v[4:5], s[28:31], 0 idxen offen lds
    v_rcp_f32 v139, v139
    v_rcp_f32 v142, v142
    v_rcp_f32 v143, v143
    v_rcp_f32 v146, v146
    v_rcp_f32 v147, v147
    v_pk_mul_f32 v[84:85], v[84:85], v[134:135]
    v_pk_mul_f32 v[88:89], v[88:89], v[138:139]
    v_pk_mul_f32 v[92:93], v[92:93], v[142:143]
    v_pk_mul_f32 v[96:97], v[96:97], v[146:147]
    v_cvt_pk_bf16_f32 v130, v84, v85
    v_cvt_pk_bf16_f32 v131, v88, v89
    v_cvt_pk_bf16_f32 v132, v92, v93
    v_cvt_pk_bf16_f32 v133, v96, v97
    s_sub_u32 s75, s75, 1
    s_cmp_eq_u32 s75, 0
    s_cbranch_scc1 L_last_odd
    s_waitcnt vmcnt(5)
    v_mfma_f32_32x32x16_bf16 v[84:99], v[8:11], v[108:111], 0
    v_exp_f32 v134, v68
    ds_read_b64_tr_b16 v[100:101], v162 offset:0
    v_exp_f32 v135, v69
    ds_read_b64_tr_b16 v[102:103], v162 offset:512
    v_exp_f32 v136, v70
    ds_read_b64_tr_b16 v[104:105], v162 offset:2048
    v_mfma_f32_32x32x16_bf16 v[84:99], v[12:15], v[112:115], v[84:99]
    v_exp_f32 v137, v71
    ds_read_b64_tr_b16 v[106:107], v162 offset:2560
    v_exp_f32 v138, v72
    ds_read_b64_tr_b16 v[108:109], v163 offset:0
    v_exp_f32 v139, v73
    ds_read_b64_tr_b16 v[110:111], v163 offset:512
    v_mfma_f32_32x32x16_bf16 v[84:99], v[116:119], v[20:23], v[84:99]
    v_exp_f32 v140, v74
    ds_read_b64_tr_b16 v[112:113], v163 offset:2048
    v_exp_f32 v141, v75
    ds_read_b64_tr_b16 v[114:115], v163 offset:2560
    v_exp_f32 v142, v76
    ds_read_b128 v[116:119], v159 offset:0
    v_mfma_f32_32x32x16_bf16 v[84:99], v[120:123], v[28:31], v[84:99]
    v_exp_f32 v143, v77
    ds_read_b32 v150, v158 offset:1024
    v_exp_f32 v144, v78
    ds_read_b32 v152, v158 offset:1088
    v_exp_f32 v145, v79
    ds_read_b128 v[120:123], v160 offset:3072
    v_mfma_f32_32x32x8_bf16 v[84:99], v[124:125], v[34:35], v[84:99]
    v_exp_f32 v146, v80
    ds_read_b32 v154, v158 offset:1152
    v_exp_f32 v147, v81
    ds_read_b32 v156, v158 offset:1216
    v_exp_f32 v148, v82
    ds_read_b64 v[124:125], v160 offset:3104
    v_exp_f32 v149, v83
    ds_read_b32 v4, v3 offset:1024
    v_pk_fma_f32 v[134:135], v[134:135], s[84:85], s[84:85] clamp
    v_pk_fma_f32 v[136:137], v[136:137], s[84:85], s[84:85] clamp
    v_pk_fma_f32 v[138:139], v[138:139], s[84:85], s[84:85] clamp
    v_pk_fma_f32 v[140:141], v[140:141], s[84:85], s[84:85] clamp
    v_pk_fma_f32 v[142:143], v[142:143], s[84:85], s[84:85] clamp
    v_pk_fma_f32 v[144:145], v[144:145], s[84:85], s[84:85] clamp
    v_pk_fma_f32 v[146:147], v[146:147], s[84:85], s[84:85] clamp
    v_pk_fma_f32 v[148:149], v[148:149], s[84:85], s[84:85] clamp
    v_pk_mul_f32 v[68:69], v[68:69], v[136:137]
    v_pk_mul_f32 v[72:73], v[72:73], v[140:141]
    v_pk_mul_f32 v[76:77], v[76:77], v[144:145]
    v_pk_mul_f32 v[80:81], v[80:81], v[148:149]
    v_pk_fma_f32 v[68:69], v[70:71], v[134:135], v[68:69]
    v_pk_fma_f32 v[72:73], v[74:75], v[138:139], v[72:73]
    v_pk_fma_f32 v[76:77], v[78:79], v[142:143], v[76:77]
    v_pk_fma_f32 v[80:81], v[82:83], v[146:147], v[80:81]
    v_pk_mul_f32 v[134:135], v[134:135], v[136:137]
    v_pk_mul_f32 v[138:139], v[138:139], v[140:141]
    v_pk_mul_f32 v[142:143], v[142:143], v[144:145]
    v_pk_mul_f32 v[146:147], v[146:147], v[148:149]
    s_waitcnt lgkmcnt(0)
    v_mfma_f32_32x32x16_bf16 v[52:67], v[130:133], v[126:129], v[52:67]
    v_rcp_f32 v134, v134
    v_rcp_f32 v135, v135
    s_add_u32 m0, s79, 0
    v_rcp_f32 v138, v138
    buffer_load_dwordx4 v[150:151], s[60:63], s78 idxen offen sc1 lds
    v_rcp_f32 v139, v139
    ds_read_b64_tr_b16 v[126:127], v161 offset:1536
    v_rcp_f32 v142, v142
    v_rcp_f32 v143, v143
    v_rcp_f32 v146, v146
    v_rcp_f32 v147, v147
    ds_read_b64_tr_b16 v[128:129], v161 offset:2304
    v_pk_mul_f32 v[68:69], v[68:69], v[134:135]
    v_pk_mul_f32 v[72:73], v[72:73], v[138:139]
    v_pk_mul_f32 v[76:77], v[76:77], v[142:143]
    v_pk_mul_f32 v[80:81], v[80:81], v[146:147]
    v_cvt_pk_bf16_f32 v130, v68, v69
    v_cvt_pk_bf16_f32 v131, v72, v73
    v_cvt_pk_bf16_f32 v132, v76, v77
    v_cvt_pk_bf16_f32 v133, v80, v81
    v_mfma_f32_32x32x16_bf16 v[68:83], v[8:11], v[100:103], 0
    v_exp_f32 v134, v84
    s_add_u32 m0, s79, 1024
    v_exp_f32 v135, v85
    buffer_load_dwordx4 v[152:153], s[60:63], s78 idxen offen sc1 lds
    v_exp_f32 v136, v86
    v_mfma_f32_32x32x16_bf16 v[68:83], v[12:15], v[104:107], v[68:83]
    v_exp_f32 v137, v87
    v_exp_f32 v138, v88
    v_exp_f32 v139, v89
    v_mfma_f32_32x32x16_bf16 v[68:83], v[116:119], v[16:19], v[68:83]
    v_exp_f32 v140, v90
    s_add_u32 m0, s79, 2048
    v_exp_f32 v141, v91
    buffer_load_dwordx4 v[154:155], s[60:63], s78 idxen offen sc1 lds
    v_exp_f32 v142, v92
    v_mfma_f32_32x32x16_bf16 v[68:83], v[120:123], v[24:27], v[68:83]
    v_exp_f32 v143, v93
    v_exp_f32 v144, v94
    v_exp_f32 v145, v95
    v_mfma_f32_32x32x8_bf16 v[68:83], v[124:125], v[32:33], v[68:83]
    v_exp_f32 v146, v96
    s_add_u32 m0, s79, 3072
    v_exp_f32 v147, v97
    buffer_load_dwordx4 v[156:157], s[60:63], s78 idxen offen sc1 lds
    v_exp_f32 v148, v98
    v_exp_f32 v149, v99
    v_pk_fma_f32 v[134:135], v[134:135], s[84:85], s[84:85] clamp
    v_pk_fma_f32 v[136:137], v[136:137], s[84:85], s[84:85] clamp
    v_pk_fma_f32 v[138:139], v[138:139], s[84:85], s[84:85] clamp
    v_pk_fma_f32 v[140:141], v[140:141], s[84:85], s[84:85] clamp
    v_pk_fma_f32 v[142:143], v[142:143], s[84:85], s[84:85] clamp
    v_pk_fma_f32 v[144:145], v[144:145], s[84:85], s[84:85] clamp
    v_pk_fma_f32 v[146:147], v[146:147], s[84:85], s[84:85] clamp
    v_pk_fma_f32 v[148:149], v[148:149], s[84:85], s[84:85] clamp
    v_pk_mul_f32 v[84:85], v[84:85], v[136:137]
    v_pk_mul_f32 v[88:89], v[88:89], v[140:141]
    v_pk_mul_f32 v[92:93], v[92:93], v[144:145]
    v_pk_mul_f32 v[96:97], v[96:97], v[148:149]
    v_pk_fma_f32 v[84:85], v[86:87], v[134:135], v[84:85]
    v_pk_fma_f32 v[88:89], v[90:91], v[138:139], v[88:89]
    v_pk_fma_f32 v[92:93], v[94:95], v[142:143], v[92:93]
    v_pk_fma_f32 v[96:97], v[98:99], v[146:147], v[96:97]
    v_pk_mul_f32 v[134:135], v[134:135], v[136:137]
    v_pk_mul_f32 v[138:139], v[138:139], v[140:141]
    v_pk_mul_f32 v[142:143], v[142:143], v[144:145]
    v_pk_mul_f32 v[146:147], v[146:147], v[148:149]
    s_waitcnt lgkmcnt(0)
    v_mfma_f32_32x32x16_bf16 v[36:51], v[130:133], v[126:129], v[36:51]
    v_rcp_f32 v134, v134
    v_rcp_f32 v135, v135
    s_add_u32 m0, s40, 0
    v_rcp_f32 v138, v138
    buffer_load_dwordx4 v[4:5], s[28:31], 0 idxen offen lds
    v_rcp_f32 v139, v139
    v_rcp_f32 v142, v142
    v_rcp_f32 v143, v143
    v_rcp_f32 v146, v146
    v_rcp_f32 v147, v147
    v_pk_mul_f32 v[84:85], v[84:85], v[134:135]
    v_pk_mul_f32 v[88:89], v[88:89], v[138:139]
    v_pk_mul_f32 v[92:93], v[92:93], v[142:143]
    v_pk_mul_f32 v[96:97], v[96:97], v[146:147]
    v_cvt_pk_bf16_f32 v130, v84, v85
    v_cvt_pk_bf16_f32 v131, v88, v89
    v_cvt_pk_bf16_f32 v132, v92, v93
    v_cvt_pk_bf16_f32 v133, v96, v97
    v_add_u32 v158, 512, v158
    v_add_u32 v3, 512, v3
    v_add_u32 v160, 3072, v160
    v_add_u32 v161, 3072, v161
    s_sub_u32 s75, s75, 1
    s_cmp_eq_u32 s75, 0
    s_cbranch_scc1 L_loop_exit
    s_sub_u32 s41, s41, 1
    s_cmp_lg_u32 s41, 0
    s_cbranch_scc1 L_loop
L_wpair:
    s_waitcnt vmcnt(5)
    v_mfma_f32_32x32x16_bf16 v[84:99], v[8:11], v[108:111], 0
    v_exp_f32 v134, v68
    ds_read_b64_tr_b16 v[100:101], v162 offset:32768
    v_exp_f32 v135, v69
    ds_read_b64_tr_b16 v[102:103], v162 offset:33280
    v_exp_f32 v136, v70
    ds_read_b64_tr_b16 v[104:105], v162 offset:34816
    v_mfma_f32_32x32x16_bf16 v[84:99], v[12:15], v[112:115], v[84:99]
    v_exp_f32 v137, v71
    ds_read_b64_tr_b16 v[106:107], v162 offset:35328
    v_exp_f32 v138, v72
    ds_read_b64_tr_b16 v[108:109], v163 offset:32768
    v_exp_f32 v139, v73
    ds_read_b64_tr_b16 v[110:111], v163 offset:33280
    v_mfma_f32_32x32x16_bf16 v[84:99], v[116:119], v[20:23], v[84:99]
    v_exp_f32 v140, v74
    ds_read_b64_tr_b16 v[112:113], v163 offset:34816
    v_exp_f32 v141, v75
    ds_read_b64_tr_b16 v[114:115], v163 offset:35328
    v_exp_f32 v142, v76
    ds_read_b128 v[116:119], v159 offset:1024
    v_mfma_f32_32x32x16_bf16 v[84:99], v[120:123], v[28:31], v[84:99]
    v_exp_f32 v143, v77
    ds_read_b32 v150, v158 offset:768
    v_exp_f32 v144, v78
    ds_read_b32 v152, v158 offset:832
    v_exp_f32 v145, v79
    ds_read_b128 v[120:123], v160 offset:1536
    v_mfma_f32_32x32x8_bf16 v[84:99], v[124:125], v[34:35], v[84:99]
    v_exp_f32 v146, v80
    ds_read_b32 v154, v158 offset:896
    v_exp_f32 v147, v81
    ds_read_b32 v156, v158 offset:960
    v_exp_f32 v148, v82
    ds_read_b64 v[124:125], v160 offset:1568
    v_exp_f32 v149, v83
    ds_read_b32 v4, v3 offset:768
    v_pk_fma_f32 v[134:135], v[134:135], s[84:85], s[84:85] clamp
    s_add_u32 s90, s20, 14684160
    s_addc_u32 s91, s21, 0
    global_load_dwordx4 v[192:195], v1, s[90:91] offset:-4096 sc1
    v_pk_fma_f32 v[136:137], v[136:137], s[84:85], s[84:85] clamp
    v_pk_fma_f32 v[138:139], v[138:139], s[84:85], s[84:85] clamp
    global_load_dwordx4 v[196:199], v1, s[90:91] offset:-3072 sc1
    v_pk_fma_f32 v[140:141], v[140:141], s[84:85], s[84:85] clamp
    v_pk_fma_f32 v[142:143], v[142:143], s[84:85], s[84:85] clamp
    global_load_dwordx4 v[200:203], v1, s[90:91] offset:-2048 sc1
    v_pk_fma_f32 v[144:145], v[144:145], s[84:85], s[84:85] clamp
    v_pk_fma_f32 v[146:147], v[146:147], s[84:85], s[84:85] clamp
    global_load_dwordx4 v[204:207], v1, s[90:91] offset:-1024 sc1
    v_pk_fma_f32 v[148:149], v[148:149], s[84:85], s[84:85] clamp
    v_pk_mul_f32 v[68:69], v[68:69], v[136:137]
    global_load_dwordx4 v[208:211], v1, s[90:91] offset:0 sc1
    v_pk_mul_f32 v[72:73], v[72:73], v[140:141]
    v_pk_mul_f32 v[76:77], v[76:77], v[144:145]
    global_load_dwordx4 v[212:215], v1, s[90:91] offset:1024 sc1
    v_pk_mul_f32 v[80:81], v[80:81], v[148:149]
    v_pk_fma_f32 v[68:69], v[70:71], v[134:135], v[68:69]
    global_load_dwordx4 v[216:219], v1, s[90:91] offset:2048 sc1
    v_pk_fma_f32 v[72:73], v[74:75], v[138:139], v[72:73]
    v_pk_fma_f32 v[76:77], v[78:79], v[142:143], v[76:77]
    global_load_dwordx4 v[220:223], v1, s[90:91] offset:3072 sc1
    v_pk_fma_f32 v[80:81], v[82:83], v[146:147], v[80:81]
    v_pk_mul_f32 v[134:135], v[134:135], v[136:137]
    v_pk_mul_f32 v[138:139], v[138:139], v[140:141]
    v_pk_mul_f32 v[142:143], v[142:143], v[144:145]
    v_pk_mul_f32 v[146:147], v[146:147], v[148:149]
    s_waitcnt lgkmcnt(0)
    v_mfma_f32_32x32x16_bf16 v[52:67], v[130:133], v[126:129], v[52:67]
    v_rcp_f32 v134, v134
    v_rcp_f32 v135, v135
    s_add_u32 m0, s79, 32768
    v_rcp_f32 v138, v138
    buffer_load_dwordx4 v[150:151], s[60:63], s78 idxen offen sc1 lds
    v_rcp_f32 v139, v139
    ds_read_b64_tr_b16 v[126:127], v161 offset:0
    v_rcp_f32 v142, v142
    v_rcp_f32 v143, v143
    v_rcp_f32 v146, v146
    v_rcp_f32 v147, v147
    ds_read_b64_tr_b16 v[128:129], v161 offset:768
    v_pk_mul_f32 v[68:69], v[68:69], v[134:135]
    v_pk_mul_f32 v[72:73], v[72:73], v[138:139]
    v_pk_mul_f32 v[76:77], v[76:77], v[142:143]
    v_pk_mul_f32 v[80:81], v[80:81], v[146:147]
    v_cvt_pk_bf16_f32 v130, v68, v69
    v_cvt_pk_bf16_f32 v131, v72, v73
    v_cvt_pk_bf16_f32 v132, v76, v77
    v_cvt_pk_bf16_f32 v133, v80, v81
    v_mfma_f32_32x32x16_bf16 v[68:83], v[8:11], v[100:103], 0
    v_exp_f32 v134, v84
    s_add_u32 m0, s79, 33792
    v_exp_f32 v135, v85
    buffer_load_dwordx4 v[152:153], s[60:63], s78 idxen offen sc1 lds
    v_exp_f32 v136, v86
    v_mfma_f32_32x32x16_bf16 v[68:83], v[12:15], v[104:107], v[68:83]
    v_exp_f32 v137, v87
    v_exp_f32 v138, v88
    v_exp_f32 v139, v89
    v_mfma_f32_32x32x16_bf16 v[68:83], v[116:119], v[16:19], v[68:83]
    v_exp_f32 v140, v90
    s_add_u32 m0, s79, 34816
    v_exp_f32 v141, v91
    buffer_load_dwordx4 v[154:155], s[60:63], s78 idxen offen sc1 lds
    v_exp_f32 v142, v92
    v_mfma_f32_32x32x16_bf16 v[68:83], v[120:123], v[24:27], v[68:83]
    v_exp_f32 v143, v93
    v_exp_f32 v144, v94
    v_exp_f32 v145, v95
    v_mfma_f32_32x32x8_bf16 v[68:83], v[124:125], v[32:33], v[68:83]
    v_exp_f32 v146, v96
    s_add_u32 m0, s79, 35840
    v_exp_f32 v147, v97
    buffer_load_dwordx4 v[156:157], s[60:63], s78 idxen offen sc1 lds
    v_exp_f32 v148, v98
    v_exp_f32 v149, v99
    v_pk_fma_f32 v[134:135], v[134:135], s[84:85], s[84:85] clamp
    v_pk_fma_f32 v[136:137], v[136:137], s[84:85], s[84:85] clamp
    v_pk_fma_f32 v[138:139], v[138:139], s[84:85], s[84:85] clamp
    v_pk_fma_f32 v[140:141], v[140:141], s[84:85], s[84:85] clamp
    v_pk_fma_f32 v[142:143], v[142:143], s[84:85], s[84:85] clamp
    v_pk_fma_f32 v[144:145], v[144:145], s[84:85], s[84:85] clamp
    v_pk_fma_f32 v[146:147], v[146:147], s[84:85], s[84:85] clamp
    v_pk_fma_f32 v[148:149], v[148:149], s[84:85], s[84:85] clamp
    v_pk_mul_f32 v[84:85], v[84:85], v[136:137]
    v_pk_mul_f32 v[88:89], v[88:89], v[140:141]
    v_pk_mul_f32 v[92:93], v[92:93], v[144:145]
    v_pk_mul_f32 v[96:97], v[96:97], v[148:149]
    v_pk_fma_f32 v[84:85], v[86:87], v[134:135], v[84:85]
    v_pk_fma_f32 v[88:89], v[90:91], v[138:139], v[88:89]
    v_pk_fma_f32 v[92:93], v[94:95], v[142:143], v[92:93]
    v_pk_fma_f32 v[96:97], v[98:99], v[146:147], v[96:97]
    v_pk_mul_f32 v[134:135], v[134:135], v[136:137]
    v_pk_mul_f32 v[138:139], v[138:139], v[140:141]
    v_pk_mul_f32 v[142:143], v[142:143], v[144:145]
    v_pk_mul_f32 v[146:147], v[146:147], v[148:149]
    s_waitcnt lgkmcnt(0)
    v_mfma_f32_32x32x16_bf16 v[36:51], v[130:133], v[126:129], v[36:51]
    v_rcp_f32 v134, v134
    v_rcp_f32 v135, v135
    s_add_u32 m0, s40, 1024
    v_rcp_f32 v138, v138
    buffer_load_dwordx4 v[4:5], s[28:31], 0 idxen offen lds
    v_rcp_f32 v139, v139
    v_rcp_f32 v142, v142
    v_rcp_f32 v143, v143
    v_rcp_f32 v146, v146
    v_rcp_f32 v147, v147
    v_pk_mul_f32 v[84:85], v[84:85], v[134:135]
    v_pk_mul_f32 v[88:89], v[88:89], v[138:139]
    v_pk_mul_f32 v[92:93], v[92:93], v[142:143]
    v_pk_mul_f32 v[96:97], v[96:97], v[146:147]
    v_cvt_pk_bf16_f32 v130, v84, v85
    v_cvt_pk_bf16_f32 v131, v88, v89
    v_cvt_pk_bf16_f32 v132, v92, v93
    v_cvt_pk_bf16_f32 v133, v96, v97
    s_sub_u32 s75, s75, 1
    s_cmp_eq_u32 s75, 0
    s_cbranch_scc1 L_last_odd
    s_setprio 0
    s_waitcnt vmcnt(5)
    v_mfma_f32_32x32x16_bf16 v[84:99], v[8:11], v[108:111], 0
    v_exp_f32 v134, v68
    ds_read_b64_tr_b16 v[100:101], v162 offset:0
    v_exp_f32 v135, v69
    ds_read_b64_tr_b16 v[102:103], v162 offset:512
    v_exp_f32 v136, v70
    ds_read_b64_tr_b16 v[104:105], v162 offset:2048
    v_mfma_f32_32x32x16_bf16 v[84:99], v[12:15], v[112:115], v[84:99]
    v_exp_f32 v137, v71
    ds_read_b64_tr_b16 v[106:107], v162 offset:2560
    v_exp_f32 v138, v72
    ds_read_b64_tr_b16 v[108:109], v163 offset:0
    v_exp_f32 v139, v73
    ds_read_b64_tr_b16 v[110:111], v163 offset:512
    v_mfma_f32_32x32x16_bf16 v[84:99], v[116:119], v[20:23], v[84:99]
    v_exp_f32 v140, v74
    ds_read_b64_tr_b16 v[112:113], v163 offset:2048
    v_exp_f32 v141, v75
    ds_read_b64_tr_b16 v[114:115], v163 offset:2560
    v_exp_f32 v142, v76
    ds_read_b128 v[116:119], v159 offset:0
    v_mfma_f32_32x32x16_bf16 v[84:99], v[120:123], v[28:31], v[84:99]
    v_exp_f32 v143, v77
    ds_read_b32 v150, v158 offset:1024
    v_exp_f32 v144, v78
    ds_read_b32 v152, v158 offset:1088
    v_exp_f32 v145, v79
    ds_read_b128 v[120:123], v160 offset:3072
    v_mfma_f32_32x32x8_bf16 v[84:99], v[124:125], v[34:35], v[84:99]
    v_exp_f32 v146, v80
    ds_read_b32 v154, v158 offset:1152
    v_exp_f32 v147, v81
    ds_read_b32 v156, v158 offset:1216
    v_exp_f32 v148, v82
    ds_read_b64 v[124:125], v160 offset:3104
    v_exp_f32 v149, v83
    ds_read_b32 v4, v3 offset:1024
    v_pk_fma_f32 v[134:135], v[134:135], s[84:85], s[84:85] clamp
    s_add_u32 s90, s20, 14692352
    s_addc_u32 s91, s21, 0
    global_load_dwordx4 v[224:227], v1, s[90:91] offset:-4096 sc1
    v_pk_fma_f32 v[136:137], v[136:137], s[84:85], s[84:85] clamp
    v_pk_fma_f32 v[138:139], v[138:139], s[84:85], s[84:85] clamp
    global_load_dwordx4 v[228:231], v1, s[90:91] offset:-3072 sc1
    v_pk_fma_f32 v[140:141], v[140:141], s[84:85], s[84:85] clamp
    v_pk_fma_f32 v[142:143], v[142:143], s[84:85], s[84:85] clamp
    global_load_dwordx4 v[232:235], v1, s[90:91] offset:-2048 sc1
    v_pk_fma_f32 v[144:145], v[144:145], s[84:85], s[84:85] clamp
    v_pk_fma_f32 v[146:147], v[146:147], s[84:85], s[84:85] clamp
    global_load_dwordx4 v[236:239], v1, s[90:91] offset:-1024 sc1
    v_pk_fma_f32 v[148:149], v[148:149], s[84:85], s[84:85] clamp
    v_pk_mul_f32 v[68:69], v[68:69], v[136:137]
    global_load_dwordx4 v[240:243], v1, s[90:91] offset:0 sc1
    v_pk_mul_f32 v[72:73], v[72:73], v[140:141]
    v_pk_mul_f32 v[76:77], v[76:77], v[144:145]
    global_load_dwordx4 v[244:247], v1, s[90:91] offset:1024 sc1
    v_pk_mul_f32 v[80:81], v[80:81], v[148:149]
    v_pk_fma_f32 v[68:69], v[70:71], v[134:135], v[68:69]
    global_load_dwordx4 v[248:251], v1, s[90:91] offset:2048 sc1
    v_pk_fma_f32 v[72:73], v[74:75], v[138:139], v[72:73]
    v_pk_fma_f32 v[76:77], v[78:79], v[142:143], v[76:77]
    global_load_dwordx4 v[252:255], v1, s[90:91] offset:3072 sc1
    v_pk_fma_f32 v[80:81], v[82:83], v[146:147], v[80:81]
    v_pk_mul_f32 v[134:135], v[134:135], v[136:137]
    v_pk_mul_f32 v[138:139], v[138:139], v[140:141]
    v_pk_mul_f32 v[142:143], v[142:143], v[144:145]
    v_pk_mul_f32 v[146:147], v[146:147], v[148:149]
    s_waitcnt lgkmcnt(0)
    v_mfma_f32_32x32x16_bf16 v[52:67], v[130:133], v[126:129], v[52:67]
    v_rcp_f32 v134, v134
    v_rcp_f32 v135, v135
    s_add_u32 m0, s79, 0
    v_rcp_f32 v138, v138
    buffer_load_dwordx4 v[150:151], s[60:63], s78 idxen offen sc1 lds
    v_rcp_f32 v139, v139
    ds_read_b64_tr_b16 v[126:127], v161 offset:1536
    v_rcp_f32 v142, v142
    v_rcp_f32 v143, v143
    v_rcp_f32 v146, v146
    v_rcp_f32 v147, v147
    ds_read_b64_tr_b16 v[128:129], v161 offset:2304
    v_pk_mul_f32 v[68:69], v[68:69], v[134:135]
    v_pk_mul_f32 v[72:73], v[72:73], v[138:139]
    v_pk_mul_f32 v[76:77], v[76:77], v[142:143]
    v_pk_mul_f32 v[80:81], v[80:81], v[146:147]
    v_cvt_pk_bf16_f32 v130, v68, v69
    v_cvt_pk_bf16_f32 v131, v72, v73
    v_cvt_pk_bf16_f32 v132, v76, v77
    v_cvt_pk_bf16_f32 v133, v80, v81
    v_mfma_f32_32x32x16_bf16 v[68:83], v[8:11], v[100:103], 0
    v_exp_f32 v134, v84
    s_add_u32 m0, s79, 1024
    v_exp_f32 v135, v85
    buffer_load_dwordx4 v[152:153], s[60:63], s78 idxen offen sc1 lds
    v_exp_f32 v136, v86
    v_mfma_f32_32x32x16_bf16 v[68:83], v[12:15], v[104:107], v[68:83]
    v_exp_f32 v137, v87
    v_exp_f32 v138, v88
    v_exp_f32 v139, v89
    v_mfma_f32_32x32x16_bf16 v[68:83], v[116:119], v[16:19], v[68:83]
    v_exp_f32 v140, v90
    s_add_u32 m0, s79, 2048
    v_exp_f32 v141, v91
    buffer_load_dwordx4 v[154:155], s[60:63], s78 idxen offen sc1 lds
    v_exp_f32 v142, v92
    v_mfma_f32_32x32x16_bf16 v[68:83], v[120:123], v[24:27], v[68:83]
    v_exp_f32 v143, v93
    v_exp_f32 v144, v94
    v_exp_f32 v145, v95
    v_mfma_f32_32x32x8_bf16 v[68:83], v[124:125], v[32:33], v[68:83]
    v_exp_f32 v146, v96
    s_add_u32 m0, s79, 3072
    v_exp_f32 v147, v97
    buffer_load_dwordx4 v[156:157], s[60:63], s78 idxen offen sc1 lds
    v_exp_f32 v148, v98
    v_exp_f32 v149, v99
    v_pk_fma_f32 v[134:135], v[134:135], s[84:85], s[84:85] clamp
    v_pk_fma_f32 v[136:137], v[136:137], s[84:85], s[84:85] clamp
    v_pk_fma_f32 v[138:139], v[138:139], s[84:85], s[84:85] clamp
    v_pk_fma_f32 v[140:141], v[140:141], s[84:85], s[84:85] clamp
    v_pk_fma_f32 v[142:143], v[142:143], s[84:85], s[84:85] clamp
    v_pk_fma_f32 v[144:145], v[144:145], s[84:85], s[84:85] clamp
    v_pk_fma_f32 v[146:147], v[146:147], s[84:85], s[84:85] clamp
    v_pk_fma_f32 v[148:149], v[148:149], s[84:85], s[84:85] clamp
    v_pk_mul_f32 v[84:85], v[84:85], v[136:137]
    v_pk_mul_f32 v[88:89], v[88:89], v[140:141]
    v_pk_mul_f32 v[92:93], v[92:93], v[144:145]
    v_pk_mul_f32 v[96:97], v[96:97], v[148:149]
    v_pk_fma_f32 v[84:85], v[86:87], v[134:135], v[84:85]
    v_pk_fma_f32 v[88:89], v[90:91], v[138:139], v[88:89]
    v_pk_fma_f32 v[92:93], v[94:95], v[142:143], v[92:93]
    v_pk_fma_f32 v[96:97], v[98:99], v[146:147], v[96:97]
    v_pk_mul_f32 v[134:135], v[134:135], v[136:137]
    v_pk_mul_f32 v[138:139], v[138:139], v[140:141]
    v_pk_mul_f32 v[142:143], v[142:143], v[144:145]
    v_pk_mul_f32 v[146:147], v[146:147], v[148:149]
    s_waitcnt lgkmcnt(0)
    v_mfma_f32_32x32x16_bf16 v[36:51], v[130:133], v[126:129], v[36:51]
    v_rcp_f32 v134, v134
    v_rcp_f32 v135, v135
    s_add_u32 m0, s40, 0
    v_rcp_f32 v138, v138
    buffer_load_dwordx4 v[4:5], s[28:31], 0 idxen offen lds
    v_rcp_f32 v139, v139
    v_rcp_f32 v142, v142
    v_rcp_f32 v143, v143
    v_rcp_f32 v146, v146
    v_rcp_f32 v147, v147
    v_pk_mul_f32 v[84:85], v[84:85], v[134:135]
    v_pk_mul_f32 v[88:89], v[88:89], v[138:139]
    v_pk_mul_f32 v[92:93], v[92:93], v[142:143]
    v_pk_mul_f32 v[96:97], v[96:97], v[146:147]
    v_cvt_pk_bf16_f32 v130, v84, v85
    v_cvt_pk_bf16_f32 v131, v88, v89
    v_cvt_pk_bf16_f32 v132, v92, v93
    v_cvt_pk_bf16_f32 v133, v96, v97
    v_add_u32 v158, 512, v158
    v_add_u32 v3, 512, v3
    v_add_u32 v160, 3072, v160
    v_add_u32 v161, 3072, v161
    s_sub_u32 s75, s75, 1
    s_mov_b32 s41, -1
    s_cmp_lg_u32 s75, 0
    s_cbranch_scc1 L_loop
    s_branch L_loop_exit
L_last_odd:
    v_add_u32 v161, 1536, v161
L_loop_exit:
    s_bitcmp0_b32 s43, 4
    s_cbranch_scc1 L_last_half
    v_mfma_f32_32x32x16_bf16 v[84:99], v[8:11], v[108:111], 0
    v_exp_f32 v134, v68
    v_exp_f32 v135, v69
    v_exp_f32 v136, v70
    v_mfma_f32_32x32x16_bf16 v[84:99], v[12:15], v[112:115], v[84:99]
    v_exp_f32 v137, v71
    v_exp_f32 v138, v72
    v_exp_f32 v139, v73
    v_mfma_f32_32x32x16_bf16 v[84:99], v[116:119], v[20:23], v[84:99]
    v_exp_f32 v140, v74
    v_exp_f32 v141, v75
    v_exp_f32 v142, v76
    v_mfma_f32_32x32x16_bf16 v[84:99], v[120:123], v[28:31], v[84:99]
    v_exp_f32 v143, v77
    v_exp_f32 v144, v78
    v_exp_f32 v145, v79
    v_mfma_f32_32x32x8_bf16 v[84:99], v[124:125], v[34:35], v[84:99]
    v_exp_f32 v146, v80
    v_exp_f32 v147, v81
    v_exp_f32 v148, v82
    v_exp_f32 v149, v83
    v_pk_fma_f32 v[134:135], v[134:135], s[84:85], s[84:85] clamp
    v_pk_fma_f32 v[136:137], v[136:137], s[84:85], s[84:85] clamp
    v_pk_fma_f32 v[138:139], v[138:139], s[84:85], s[84:85] clamp
    v_pk_fma_f32 v[140:141], v[140:141], s[84:85], s[84:85] clamp
    v_pk_fma_f32 v[142:143], v[142:143], s[84:85], s[84:85] clamp
    v_pk_fma_f32 v[144:145], v[144:145], s[84:85], s[84:85] clamp
    v_pk_fma_f32 v[146:147], v[146:147], s[84:85], s[84:85] clamp
    v_pk_fma_f32 v[148:149], v[148:149], s[84:85], s[84:85] clamp
    v_pk_mul_f32 v[68:69], v[68:69], v[136:137]
    v_pk_mul_f32 v[72:73], v[72:73], v[140:141]
    v_pk_mul_f32 v[76:77], v[76:77], v[144:145]
    v_pk_mul_f32 v[80:81], v[80:81], v[148:149]
    v_pk_fma_f32 v[68:69], v[70:71], v[134:135], v[68:69]
    v_pk_fma_f32 v[72:73], v[74:75], v[138:139], v[72:73]
    v_pk_fma_f32 v[76:77], v[78:79], v[142:143], v[76:77]
    v_pk_fma_f32 v[80:81], v[82:83], v[146:147], v[80:81]
    v_pk_mul_f32 v[134:135], v[134:135], v[136:137]
    v_pk_mul_f32 v[138:139], v[138:139], v[140:141]
    v_pk_mul_f32 v[142:143], v[142:143], v[144:145]
    v_pk_mul_f32 v[146:147], v[146:147], v[148:149]
    s_nop 0
    v_mfma_f32_32x32x16_bf16 v[52:67], v[130:133], v[126:129], v[52:67]
    v_rcp_f32 v134, v134
    v_rcp_f32 v135, v135
    v_rcp_f32 v138, v138
    ds_read_b64_tr_b16 v[126:127], v161 offset:0
    v_rcp_f32 v139, v139
    ds_read_b64_tr_b16 v[128:129], v161 offset:768
    v_rcp_f32 v142, v142
    v_rcp_f32 v143, v143
    v_rcp_f32 v146, v146
    v_rcp_f32 v147, v147
    v_pk_mul_f32 v[68:69], v[68:69], v[134:135]
    v_pk_mul_f32 v[72:73], v[72:73], v[138:139]
    v_pk_mul_f32 v[76:77], v[76:77], v[142:143]
    v_pk_mul_f32 v[80:81], v[80:81], v[146:147]
    v_cvt_pk_bf16_f32 v130, v68, v69
    v_cvt_pk_bf16_f32 v131, v72, v73
    v_cvt_pk_bf16_f32 v132, v76, v77
    v_cvt_pk_bf16_f32 v133, v80, v81
    v_exp_f32 v134, v84
    v_exp_f32 v135, v85
    v_exp_f32 v136, v86
    v_exp_f32 v137, v87
    v_exp_f32 v138, v88
    v_exp_f32 v139, v89
    v_exp_f32 v140, v90
    v_exp_f32 v141, v91
    v_exp_f32 v142, v92
    v_exp_f32 v143, v93
    v_exp_f32 v144, v94
    v_exp_f32 v145, v95
    v_exp_f32 v146, v96
    v_exp_f32 v147, v97
    v_exp_f32 v148, v98
    v_exp_f32 v149, v99
    v_pk_fma_f32 v[134:135], v[134:135], s[84:85], s[84:85] clamp
    v_pk_fma_f32 v[136:137], v[136:137], s[84:85], s[84:85] clamp
    v_pk_fma_f32 v[138:139], v[138:139], s[84:85], s[84:85] clamp
    v_pk_fma_f32 v[140:141], v[140:141], s[84:85], s[84:85] clamp
    v_pk_fma_f32 v[142:143], v[142:143], s[84:85], s[84:85] clamp
    v_pk_fma_f32 v[144:145], v[144:145], s[84:85], s[84:85] clamp
    v_pk_fma_f32 v[146:147], v[146:147], s[84:85], s[84:85] clamp
    v_pk_fma_f32 v[148:149], v[148:149], s[84:85], s[84:85] clamp
    v_pk_mul_f32 v[84:85], v[84:85], v[136:137]
    v_pk_mul_f32 v[88:89], v[88:89], v[140:141]
    v_pk_mul_f32 v[92:93], v[92:93], v[144:145]
    v_pk_mul_f32 v[96:97], v[96:97], v[148:149]
    v_pk_fma_f32 v[84:85], v[86:87], v[134:135], v[84:85]
    v_pk_fma_f32 v[88:89], v[90:91], v[138:139], v[88:89]
    v_pk_fma_f32 v[92:93], v[94:95], v[142:143], v[92:93]
    v_pk_fma_f32 v[96:97], v[98:99], v[146:147], v[96:97]
    v_pk_mul_f32 v[134:135], v[134:135], v[136:137]
    v_pk_mul_f32 v[138:139], v[138:139], v[140:141]
    v_pk_mul_f32 v[142:143], v[142:143], v[144:145]
    v_pk_mul_f32 v[146:147], v[146:147], v[148:149]
    s_waitcnt lgkmcnt(0)
    v_mfma_f32_32x32x16_bf16 v[36:51], v[130:133], v[126:129], v[36:51]
    v_rcp_f32 v134, v134
    v_rcp_f32 v135, v135
    v_rcp_f32 v138, v138
    v_rcp_f32 v139, v139
    v_rcp_f32 v142, v142
    v_rcp_f32 v143, v143
    v_rcp_f32 v146, v146
    v_rcp_f32 v147, v147
    v_pk_mul_f32 v[84:85], v[84:85], v[134:135]
    v_pk_mul_f32 v[88:89], v[88:89], v[138:139]
    v_pk_mul_f32 v[92:93], v[92:93], v[142:143]
    v_pk_mul_f32 v[96:97], v[96:97], v[146:147]
    v_cvt_pk_bf16_f32 v130, v84, v85
    v_cvt_pk_bf16_f32 v131, v88, v89
    v_cvt_pk_bf16_f32 v132, v92, v93
    v_cvt_pk_bf16_f32 v133, v96, v97
    s_branch L_last_done
L_last_half:
    v_mfma_f32_32x32x16_bf16 v[84:99], v[8:11], v[108:111], 0
    v_exp_f32 v134, v68
    v_exp_f32 v135, v69
    v_mfma_f32_32x32x16_bf16 v[84:99], v[12:15], v[112:115], v[84:99]
    v_exp_f32 v136, v70
    v_exp_f32 v137, v71
    v_mfma_f32_32x32x16_bf16 v[84:99], v[116:119], v[20:23], v[84:99]
    v_exp_f32 v138, v72
    v_exp_f32 v139, v73
    v_mfma_f32_32x32x16_bf16 v[84:99], v[120:123], v[28:31], v[84:99]
    v_exp_f32 v140, v74
    v_mfma_f32_32x32x8_bf16 v[84:99], v[124:125], v[34:35], v[84:99]
    v_exp_f32 v141, v75
    v_pk_fma_f32 v[134:135], v[134:135], s[84:85], s[84:85] clamp
    v_pk_fma_f32 v[136:137], v[136:137], s[84:85], s[84:85] clamp
    v_pk_fma_f32 v[138:139], v[138:139], s[84:85], s[84:85] clamp
    v_pk_fma_f32 v[140:141], v[140:141], s[84:85], s[84:85] clamp
    v_pk_mul_f32 v[68:69], v[68:69], v[136:137]
    v_pk_mul_f32 v[72:73], v[72:73], v[140:141]
    v_pk_fma_f32 v[68:69], v[70:71], v[134:135], v[68:69]
    v_pk_fma_f32 v[72:73], v[74:75], v[138:139], v[72:73]
    v_pk_mul_f32 v[134:135], v[134:135], v[136:137]
    v_pk_mul_f32 v[138:139], v[138:139], v[140:141]
    s_nop 0
    v_mfma_f32_32x32x16_bf16 v[52:67], v[130:133], v[126:129], v[52:67]
    v_rcp_f32 v134, v134
    v_rcp_f32 v135, v135
    v_rcp_f32 v138, v138
    ds_read_b64_tr_b16 v[126:127], v161 offset:0
    v_rcp_f32 v139, v139
    ds_read_b64_tr_b16 v[128:129], v161 offset:768
    v_pk_mul_f32 v[68:69], v[68:69], v[134:135]
    v_pk_mul_f32 v[72:73], v[72:73], v[138:139]
    v_cvt_pk_bf16_f32 v130, v68, v69
    v_cvt_pk_bf16_f32 v131, v72, v73
    v_mov_b32 v132, 0
    v_mov_b32 v133, 0
    v_exp_f32 v134, v84
    v_exp_f32 v135, v85
    v_exp_f32 v136, v86
    v_exp_f32 v137, v87
    v_exp_f32 v138, v88
    v_exp_f32 v139, v89
    v_exp_f32 v140, v90
    v_exp_f32 v141, v91
    v_pk_fma_f32 v[134:135], v[134:135], s[84:85], s[84:85] clamp
    v_pk_fma_f32 v[136:137], v[136:137], s[84:85], s[84:85] clamp
    v_pk_fma_f32 v[138:139], v[138:139], s[84:85], s[84:85] clamp
    v_pk_fma_f32 v[140:141], v[140:141], s[84:85], s[84:85] clamp
    v_pk_mul_f32 v[84:85], v[84:85], v[136:137]
    v_pk_mul_f32 v[88:89], v[88:89], v[140:141]
    v_pk_fma_f32 v[84:85], v[86:87], v[134:135], v[84:85]
    v_pk_fma_f32 v[88:89], v[90:91], v[138:139], v[88:89]
    v_pk_mul_f32 v[134:135], v[134:135], v[136:137]
    v_pk_mul_f32 v[138:139], v[138:139], v[140:141]
    s_waitcnt lgkmcnt(0)
    v_mfma_f32_32x32x16_bf16 v[36:51], v[130:133], v[126:129], v[36:51]
    v_rcp_f32 v134, v134
    v_rcp_f32 v135, v135
    v_rcp_f32 v138, v138
    v_rcp_f32 v139, v139
    v_pk_mul_f32 v[84:85], v[84:85], v[134:135]
    v_pk_mul_f32 v[88:89], v[88:89], v[138:139]
    v_cvt_pk_bf16_f32 v130, v84, v85
    v_cvt_pk_bf16_f32 v131, v88, v89
L_last_done:
    s_nop 1
    v_mfma_f32_32x32x16_bf16 v[52:67], v[130:133], v[126:129], v[52:67]
L_loop_done:
    s_cmp_lt_i32 s41, 0
    s_cbranch_scc1 L_wdone
    s_waitcnt vmcnt(0)
    s_add_u32 s90, s20, 14684160
    s_addc_u32 s91, s21, 0
    global_load_dwordx4 v[192:195], v1, s[90:91] offset:-4096 sc1
    global_load_dwordx4 v[196:199], v1, s[90:91] offset:-3072 sc1
    global_load_dwordx4 v[200:203], v1, s[90:91] offset:-2048 sc1
    global_load_dwordx4 v[204:207], v1, s[90:91] offset:-1024 sc1
    global_load_dwordx4 v[208:211], v1, s[90:91] offset:0 sc1
    global_load_dwordx4 v[212:215], v1, s[90:91] offset:1024 sc1
    global_load_dwordx4 v[216:219], v1, s[90:91] offset:2048 sc1
    global_load_dwordx4 v[220:223], v1, s[90:91] offset:3072 sc1
    s_add_u32 s90, s20, 14692352
    s_addc_u32 s91, s21, 0
    global_load_dwordx4 v[224:227], v1, s[90:91] offset:-4096 sc1
    global_load_dwordx4 v[228:231], v1, s[90:91] offset:-3072 sc1
    global_load_dwordx4 v[232:235], v1, s[90:91] offset:-2048 sc1
    global_load_dwordx4 v[236:239], v1, s[90:91] offset:-1024 sc1
    global_load_dwordx4 v[240:243], v1, s[90:91] offset:0 sc1
    global_load_dwordx4 v[244:247], v1, s[90:91] offset:1024 sc1
    global_load_dwordx4 v[248:251], v1, s[90:91] offset:2048 sc1
    global_load_dwordx4 v[252:255], v1, s[90:91] offset:3072 sc1
L_wdone:
    s_cmp_lg_u32 s81, 0
    s_cbranch_scc1 L_slow_next
L_epi:
    v_and_b32 v6, 31, v0
    v_cmp_gt_u32 vcc, 20, v6
    v_mul_u32_u24 v6, 160, v6
    v_bfe_u32 v7, v0, 5, 1
    v_lshl_add_u32 v6, v7, 3, v6
    v_add_u32 v6, s79, v6
    v_and_b32 v7, 15, v0
    v_mul_u32_u24 v150, 160, v7
    v_and_b32 v151, 48, v0
    v_add_u32 v150, v150, v151
    v_add_u32 v152, 18304, v150
    v_cmp_lt_u32 s[88:89], 3, v7
    v_add_u32 v151, 2560, v150
    v_add_u32 v153, 15744, v150
    v_cndmask_b32 v151, v151, v153, s[88:89]
    v_cvt_pk_bf16_f32 v134, v36, v37
    v_cvt_pk_bf16_f32 v135, v38, v39
    v_cvt_pk_bf16_f32 v136, v40, v41
    v_cvt_pk_bf16_f32 v137, v42, v43
    v_cvt_pk_bf16_f32 v138, v44, v45
    v_cvt_pk_bf16_f32 v139, v46, v47
    v_cvt_pk_bf16_f32 v140, v48, v49
    v_cvt_pk_bf16_f32 v141, v50, v51
    v_cvt_pk_bf16_f32 v142, v52, v53
    v_cvt_pk_bf16_f32 v143, v54, v55
    v_cvt_pk_bf16_f32 v144, v56, v57
    v_cvt_pk_bf16_f32 v145, v58, v59
    v_cvt_pk_bf16_f32 v146, v60, v61
    v_cvt_pk_bf16_f32 v147, v62, v63
    v_cvt_pk_bf16_f32 v148, v64, v65
    v_cvt_pk_bf16_f32 v149, v66, v67
    s_waitcnt vmcnt(0)
    s_and_saveexec_b64 s[88:89], vcc
    ds_write_b64 v6, v[134:135] offset:0
    ds_write_b64 v6, v[136:137] offset:16
    ds_write_b64 v6, v[138:139] offset:32
    ds_write_b64 v6, v[140:141] offset:48
    ds_write_b64 v6, v[142:143] offset:64
    ds_write_b64 v6, v[144:145] offset:80
    ds_write_b64 v6, v[146:147] offset:96
    ds_write_b64 v6, v[148:149] offset:112
    s_mov_b64 exec, -1
    s_waitcnt lgkmcnt(0)
    s_barrier
    ds_read_b128 v[36:39], v150 offset:0
    ds_read_b128 v[40:43], v150 offset:64
    ds_read_b128 v[44:47], v150 offset:4096
    ds_read_b128 v[48:51], v150 offset:4160
    ds_read_b128 v[52:55], v150 offset:8192
    ds_read_b128 v[56:59], v150 offset:8256
    ds_read_b128 v[60:63], v150 offset:12288
    ds_read_b128 v[64:67], v150 offset:12352
    v_and_b32 v6, 15, v0
    v_lshlrev_b32 v6, 9, v6
    v_lshrrev_b32 v7, 4, v0
    v_lshl_add_u32 v6, v7, 4, v6
    s_mul_i32 s71, s2, 20480
    s_waitcnt lgkmcnt(7)
    v_mfma_f32_16x16x32_bf16 v[164:167], v[192:195], v[36:39], v[164:167]
    ds_read_b128 v[68:71], v151 offset:0
    v_mfma_f32_16x16x32_bf16 v[168:171], v[196:199], v[36:39], v[168:171]
    ds_read_b128 v[72:75], v151 offset:64
    s_waitcnt lgkmcnt(8)
    v_mfma_f32_16x16x32_bf16 v[164:167], v[200:203], v[40:43], v[164:167]
    ds_read_b128 v[76:79], v151 offset:4096
    v_mfma_f32_16x16x32_bf16 v[168:171], v[204:207], v[40:43], v[168:171]
    ds_read_b128 v[80:83], v151 offset:4160
    s_waitcnt lgkmcnt(9)
    v_mfma_f32_16x16x32_bf16 v[164:167], v[208:211], v[44:47], v[164:167]
    ds_read_b128 v[84:87], v151 offset:8192
    v_mfma_f32_16x16x32_bf16 v[168:171], v[212:215], v[44:47], v[168:171]
    ds_read_b128 v[88:91], v151 offset:8256
    s_waitcnt lgkmcnt(10)
    v_mfma_f32_16x16x32_bf16 v[164:167], v[216:219], v[48:51], v[164:167]
    ds_read_b128 v[92:95], v151 offset:12288
    v_mfma_f32_16x16x32_bf16 v[168:171], v[220:223], v[48:51], v[168:171]
    ds_read_b128 v[96:99], v151 offset:12352
    s_waitcnt lgkmcnt(11)
    v_mfma_f32_16x16x32_bf16 v[164:167], v[224:227], v[52:55], v[164:167]
    ds_read_b128 v[100:103], v152 offset:0
    v_mfma_f32_16x16x32_bf16 v[168:171], v[228:231], v[52:55], v[168:171]
    ds_read_b128 v[104:107], v152 offset:64
    s_waitcnt lgkmcnt(12)
    v_mfma_f32_16x16x32_bf16 v[164:167], v[232:235], v[56:59], v[164:167]
    ds_read_b128 v[108:111], v152 offset:4096
    v_mfma_f32_16x16x32_bf16 v[168:171], v[236:239], v[56:59], v[168:171]
    ds_read_b128 v[112:115], v152 offset:4160
    s_waitcnt lgkmcnt(13)
    v_mfma_f32_16x16x32_bf16 v[164:167], v[240:243], v[60:63], v[164:167]
    ds_read_b128 v[116:119], v152 offset:8192
    v_mfma_f32_16x16x32_bf16 v[168:171], v[244:247], v[60:63], v[168:171]
    ds_read_b128 v[120:123], v152 offset:8256
    s_waitcnt lgkmcnt(14)
    v_mfma_f32_16x16x32_bf16 v[164:167], v[248:251], v[64:67], v[164:167]
    ds_read_b128 v[124:127], v152 offset:12288
    v_mfma_f32_16x16x32_bf16 v[168:171], v[252:255], v[64:67], v[168:171]
    ds_read_b128 v[128:131], v152 offset:12352
    s_waitcnt lgkmcnt(0)
    v_mfma_f32_16x16x32_bf16 v[172:175], v[192:195], v[68:71], v[172:175]
    v_mfma_f32_16x16x32_bf16 v[176:179], v[196:199], v[68:71], v[176:179]
    v_mfma_f32_16x16x32_bf16 v[172:175], v[200:203], v[72:75], v[172:175]
    v_mfma_f32_16x16x32_bf16 v[176:179], v[204:207], v[72:75], v[176:179]
    v_exp_f32 v134, v164
    v_exp_f32 v135, v165
    v_exp_f32 v136, v166
    v_mfma_f32_16x16x32_bf16 v[172:175], v[208:211], v[76:79], v[172:175]
    v_exp_f32 v137, v167
    v_exp_f32 v138, v168
    v_exp_f32 v139, v169
    v_mfma_f32_16x16x32_bf16 v[176:179], v[212:215], v[76:79], v[176:179]
    v_exp_f32 v140, v170
    v_exp_f32 v141, v171
    v_fma_f32 v134, v134, s86, s86
    v_mfma_f32_16x16x32_bf16 v[172:175], v[216:219], v[80:83], v[172:175]
    v_fma_f32 v135, v135, s86, s86
    v_fma_f32 v136, v136, s86, s86
    v_fma_f32 v137, v137, s86, s86
    v_mfma_f32_16x16x32_bf16 v[176:179], v[220:223], v[80:83], v[176:179]
    v_fma_f32 v138, v138, s86, s86
    v_fma_f32 v139, v139, s86, s86
    v_fma_f32 v140, v140, s86, s86
    v_mfma_f32_16x16x32_bf16 v[172:175], v[224:227], v[84:87], v[172:175]
    v_fma_f32 v141, v141, s86, s86
    v_rcp_f32 v134, v134
    v_rcp_f32 v135, v135
    v_mfma_f32_16x16x32_bf16 v[176:179], v[228:231], v[84:87], v[176:179]
    v_rcp_f32 v136, v136
    v_rcp_f32 v137, v137
    v_rcp_f32 v138, v138
    v_mfma_f32_16x16x32_bf16 v[172:175], v[232:235], v[88:91], v[172:175]
    v_rcp_f32 v139, v139
    v_rcp_f32 v140, v140
    v_rcp_f32 v141, v141
    v_mfma_f32_16x16x32_bf16 v[176:179], v[236:239], v[88:91], v[176:179]
    v_mul_f32 v164, v164, v134
    v_mul_f32 v165, v165, v135
    v_mul_f32 v166, v166, v136
    v_mfma_f32_16x16x32_bf16 v[172:175], v[240:243], v[92:95], v[172:175]
    v_mul_f32 v167, v167, v137
    v_mul_f32 v168, v168, v138
    v_mul_f32 v169, v169, v139
    v_mfma_f32_16x16x32_bf16 v[176:179], v[244:247], v[92:95], v[176:179]
    v_mul_f32 v170, v170, v140
    v_mul_f32 v171, v171, v141
    v_cvt_pk_bf16_f32 v164, v164, v168
    v_mfma_f32_16x16x32_bf16 v[172:175], v[248:251], v[96:99], v[172:175]
    v_cvt_pk_bf16_f32 v165, v165, v169
    v_cvt_pk_bf16_f32 v166, v166, v170
    v_cvt_pk_bf16_f32 v167, v167, v171
    v_mfma_f32_16x16x32_bf16 v[176:179], v[252:255], v[96:99], v[176:179]
    buffer_store_dwordx4 v[164:167], v6, s[48:51], s71 offen nt
    s_add_u32 s71, s71, 8192
    v_mfma_f32_16x16x32_bf16 v[180:183], v[192:195], v[100:103], v[180:183]
    v_mfma_f32_16x16x32_bf16 v[184:187], v[196:199], v[100:103], v[184:187]
    v_mfma_f32_16x16x32_bf16 v[180:183], v[200:203], v[104:107], v[180:183]
    v_mfma_f32_16x16x32_bf16 v[184:187], v[204:207], v[104:107], v[184:187]
    v_exp_f32 v134, v172
    v_exp_f32 v135, v173
    v_exp_f32 v136, v174
    v_mfma_f32_16x16x32_bf16 v[180:183], v[208:211], v[108:111], v[180:183]
    v_exp_f32 v137, v175
    v_exp_f32 v138, v176
    v_exp_f32 v139, v177
    v_mfma_f32_16x16x32_bf16 v[184:187], v[212:215], v[108:111], v[184:187]
    v_exp_f32 v140, v178
    v_exp_f32 v141, v179
    v_fma_f32 v134, v134, s86, s86
    v_mfma_f32_16x16x32_bf16 v[180:183], v[216:219], v[112:115], v[180:183]
    v_fma_f32 v135, v135, s86, s86
    v_fma_f32 v136, v136, s86, s86
    v_fma_f32 v137, v137, s86, s86
    v_mfma_f32_16x16x32_bf16 v[184:187], v[220:223], v[112:115], v[184:187]
    v_fma_f32 v138, v138, s86, s86
    v_fma_f32 v139, v139, s86, s86
    v_fma_f32 v140, v140, s86, s86
    v_mfma_f32_16x16x32_bf16 v[180:183], v[224:227], v[116:119], v[180:183]
    v_fma_f32 v141, v141, s86, s86
    v_rcp_f32 v134, v134
    v_rcp_f32 v135, v135
    v_mfma_f32_16x16x32_bf16 v[184:187], v[228:231], v[116:119], v[184:187]
    v_rcp_f32 v136, v136
    v_rcp_f32 v137, v137
    v_rcp_f32 v138, v138
    v_mfma_f32_16x16x32_bf16 v[180:183], v[232:235], v[120:123], v[180:183]
    v_rcp_f32 v139, v139
    v_rcp_f32 v140, v140
    v_rcp_f32 v141, v141
    v_mfma_f32_16x16x32_bf16 v[184:187], v[236:239], v[120:123], v[184:187]
    v_mul_f32 v172, v172, v134
    v_mul_f32 v173, v173, v135
    v_mul_f32 v174, v174, v136
    v_mfma_f32_16x16x32_bf16 v[180:183], v[240:243], v[124:127], v[180:183]
    v_mul_f32 v175, v175, v137
    v_mul_f32 v176, v176, v138
    v_mul_f32 v177, v177, v139
    v_mfma_f32_16x16x32_bf16 v[184:187], v[244:247], v[124:127], v[184:187]
    v_mul_f32 v178, v178, v140
    v_mul_f32 v179, v179, v141
    v_cvt_pk_bf16_f32 v172, v172, v176
    v_mfma_f32_16x16x32_bf16 v[180:183], v[248:251], v[128:131], v[180:183]
    v_cvt_pk_bf16_f32 v173, v173, v177
    v_cvt_pk_bf16_f32 v174, v174, v178
    v_cvt_pk_bf16_f32 v175, v175, v179
    v_mfma_f32_16x16x32_bf16 v[184:187], v[252:255], v[128:131], v[184:187]
    buffer_store_dwordx4 v[172:175], v6, s[48:51], s71 offen nt
    s_add_u32 s71, s71, 8192
    s_nop 7
    v_exp_f32 v134, v180
    v_exp_f32 v135, v181
    v_exp_f32 v136, v182
    v_exp_f32 v137, v183
    v_exp_f32 v138, v184
    v_exp_f32 v139, v185
    v_exp_f32 v140, v186
    v_exp_f32 v141, v187
    v_pk_fma_f32 v[134:135], v[134:135], s[86:87], s[86:87]
    v_pk_fma_f32 v[136:137], v[136:137], s[86:87], s[86:87]
    v_pk_fma_f32 v[138:139], v[138:139], s[86:87], s[86:87]
    v_pk_fma_f32 v[140:141], v[140:141], s[86:87], s[86:87]
    v_rcp_f32 v134, v134
    v_rcp_f32 v135, v135
    v_rcp_f32 v136, v136
    v_rcp_f32 v137, v137
    v_rcp_f32 v138, v138
    v_rcp_f32 v139, v139
    v_rcp_f32 v140, v140
    v_rcp_f32 v141, v141
    v_pk_mul_f32 v[180:181], v[180:181], v[134:135]
    v_pk_mul_f32 v[182:183], v[182:183], v[136:137]
    v_pk_mul_f32 v[184:185], v[184:185], v[138:139]
    v_pk_mul_f32 v[186:187], v[186:187], v[140:141]
    v_cvt_pk_bf16_f32 v180, v180, v184
    v_cvt_pk_bf16_f32 v181, v181, v185
    v_cvt_pk_bf16_f32 v182, v182, v186
    v_cvt_pk_bf16_f32 v183, v183, v187
    s_mov_b32 exec_lo, 0x00ff00ff
    s_mov_b32 exec_hi, 0x00ff00ff
    buffer_store_dwordx4 v[180:183], v6, s[48:51], s71 offen nt
    s_add_u32 s71, s71, 8192
L_end:
    s_endpgm
L_slow_first:
    s_mov_b32 s82, 0
    s_branch L_slow_round
L_slow_next:
    s_add_u32 s82, s82, 1
    s_cmp_ge_u32 s82, 625
    s_cbranch_scc1 L_epi
L_slow_round:
    s_lshl_b32 s71, s82, 8
    v_add_u32 v152, s71, v0
    v_lshlrev_b32 v6, 2, v152
    buffer_load_dword v102, v6, s[36:39], 0 offen
    buffer_load_dword v100, v6, s[32:35], 0 offen
    s_waitcnt vmcnt(0) lgkmcnt(0)
    s_barrier
    v_mov_b32 v134, 0
    v_mov_b32 v135, 0
    v_mov_b32 v136, 0
    v_mov_b32 v137, 0
    v_lshlrev_b32 v6, 4, v0
    v_add_u32 v6, 113920, v6
    ds_write_b128 v6, v[134:137] offset:0
    ds_write_b128 v6, v[134:137] offset:8192
    ds_write_b128 v6, v[134:137] offset:16384
    ds_write_b128 v6, v[134:137] offset:24576
    v_cmp_gt_u32 vcc, 449, v0
    s_and_saveexec_b64 s[88:89], vcc
    ds_write_b128 v6, v[134:137] offset:32768
    s_mov_b64 exec, -1
    v_cmp_gt_u32 vcc, 20, v0
    s_and_saveexec_b64 s[88:89], vcc
    ds_write_b128 v6, v[134:137] offset:47376
    s_mov_b64 exec, -1
    v_mov_b32 v138, 10000
    v_mov_b32 v139, 160000
    v_mov_b32 v140, 10000
    v_mov_b32 v141, 160000
    v_cmp_gt_u32 vcc, 464, v0
    s_and_saveexec_b64 s[88:89], vcc
    ds_write_b128 v6, v[138:141] offset:39952
    s_mov_b64 exec, -1
    s_mul_i32 s71, s2, 40
    v_subrev_u32 v102, s71, v102
    v_cmp_lt_u32 vcc, 19, v102
    v_add_u32 v6, 12, v102
    s_nop 0
    v_cndmask_b32 v6, v102, v6, vcc
    v_lshl_or_b32 v100, v6, 14, v100
    v_cmp_gt_u32 vcc, 40, v102
    s_cmp_lt_u32 s68, 4
    s_cselect_b64 s[88:89], -1, 0
    s_and_b64 vcc, vcc, s[88:89]
    v_cndmask_b32 v100, -1, v100, vcc
    s_waitcnt lgkmcnt(0)
    s_barrier
    v_mov_b32 v135, 1
    v_cmpx_le_i32 vcc, 0, v100
    v_bfe_u32 v134, v100, 14, 6
    v_lshlrev_b32 v134, 2, v134
    v_add_u32 v134, 161296, v134
    ds_add_rtn_u32 v101, v134, v135
    s_mov_b64 exec, -1
    s_waitcnt lgkmcnt(0)
    s_barrier
    v_and_b32 v134, 63, v0
    v_lshlrev_b32 v134, 2, v134
    v_add_u32 v134, 161296, v134
    ds_read_b32 v135, v134
    v_mov_b32 v134, 161552
    ds_read_b32 v136, v134
    s_waitcnt lgkmcnt(0)
    v_add_u32 v135, 1, v135
    v_and_b32 v135, -2, v135
    v_mov_b32 v153, v135
    s_nop 1
    v_add_u32_dpp v153, v153, v153 row_shr:1 row_mask:0xf bank_mask:0xf bound_ctrl:0
    s_nop 1
    v_add_u32_dpp v153, v153, v153 row_shr:2 row_mask:0xf bank_mask:0xf bound_ctrl:0
    s_nop 1
    v_add_u32_dpp v153, v153, v153 row_shr:4 row_mask:0xf bank_mask:0xf bound_ctrl:0
    s_nop 1
    v_add_u32_dpp v153, v153, v153 row_shr:8 row_mask:0xf bank_mask:0xf bound_ctrl:0
    s_nop 1
    v_add_u32_dpp v153, v153, v153 row_bcast:15 row_mask:0xa bank_mask:0xf
    s_nop 0
    v_readlane_b32 s71, v153, 31
    v_readlane_b32 s72, v153, 63
    v_readfirstlane_b32 s73, v136
    v_readlane_b32 s42, v153, 15
    v_readlane_b32 s43, v153, 47
    v_sub_u32 v153, v153, v135
    s_mov_b32 exec_lo, 0
    v_add_u32 v153, 416, v153
    s_mov_b32 exec_lo, -1
    s_cmp_eq_u32 s70, 0
    s_cselect_b32 s74, s71, s72
    s_cselect_b32 s42, s42, s43
    s_sub_u32 s43, s74, 1
    s_add_u32 s74, s74, 31
    s_lshr_b32 s74, s74, 5
    v_bfe_u32 v134, v100, 14, 6
    v_lshlrev_b32 v138, 2, v134
    ds_bpermute_b32 v138, v138, v153
    s_mov_b32 s83, 0xd8d8d8d8
    v_mov_b32 v146, 0x2b80
    s_waitcnt lgkmcnt(0)
    v_cmpx_le_i32 vcc, 0, v100
    v_add_u32 v138, v138, v101
    v_lshlrev_b32 v142, 1, v138
    v_bfe_u32 v142, s83, v142, 2
    v_bfi_b32 v138, 3, v142, v138
    v_and_b32 v144, 0x3fff, v100
    v_lshrrev_b32 v145, 20, v100
    v_add_u32 v145, v145, v152
    v_lshlrev_b32 v142, 3, v138
    v_add_u32 v142, 153872, v142
    ds_write_b64 v142, v[144:145]
    v_and_b32 v143, 31, v134
    v_mad_u32_u24 v143, v138, 24, v143
    v_lshlrev_b32 v143, 1, v143
    v_add_u32 v143, 113920, v143
    ds_write_b16 v143, v146
    s_mov_b64 exec, -1
    s_waitcnt lgkmcnt(0)
    s_barrier
    s_mul_i32 s71, s70, 416
    v_bfe_u32 v6, v0, 3, 3
    v_add_u32 v6, s71, v6
    v_lshlrev_b32 v158, 3, v6
    v_add_u32 v158, 153872, v158
    v_and_b32 v6, 31, v0
    v_add_u32 v6, s71, v6
    v_bfe_u32 v7, v0, 5, 1
    v_mul_u32_u24 v160, 48, v6
    v_lshl_add_u32 v160, v7, 4, v160
    v_add_u32 v160, 113920, v160
    v_bfe_u32 v159, v0, 3, 1
    v_xor_b32 v159, v159, v7
    v_lshlrev_b32 v159, 4, v159
    v_and_b32 v6, 31, v0
    v_lshl_add_u32 v159, v6, 5, v159
    s_lshl_b32 s40, s68, 11
    s_add_u32 s40, s40, 91648
    v_add_u32 v159, s40, v159
    v_bfe_u32 v3, v0, 1, 5
    v_add_u32 v3, s71, v3
    v_lshlrev_b32 v3, 3, v3
    v_add_u32 v3, 153876, v3
    v_lshrrev_b32 v5, 4, v0
    v_xor_b32 v5, v5, v0
    v_and_b32 v5, 1, v5
    v_lshlrev_b32 v5, 4, v5
    v_bfe_u32 v6, v0, 2, 1
    v_lshl_add_u32 v6, v7, 2, v6
    v_and_b32 v7, 8, v0
    v_add3_u32 v6, v6, v7, s71
    v_mul_u32_u24 v161, 48, v6
    v_and_b32 v6, 3, v0
    v_lshl_add_u32 v161, v6, 3, v161
    v_and_b32 v6, 16, v0
    v_lshl_add_u32 v161, v6, 1, v161
    v_add_u32 v161, 113920, v161
    v_bfe_u32 v6, v0, 4, 1
    v_lshlrev_b32 v6, 2, v6
    v_and_b32 v7, 7, v0
    v_xor_b32 v6, v6, v7
    v_lshlrev_b32 v151, 4, v6
    v_lshlrev_b32 v153, 4, v6
    v_lshlrev_b32 v155, 4, v6
    v_lshlrev_b32 v157, 4, v6
    ds_read_b32 v150, v158 offset:0
    ds_read_b32 v152, v158 offset:64
    ds_read_b32 v154, v158 offset:128
    ds_read_b32 v156, v158 offset:192
    ds_read_b32 v4, v3 offset:0
    s_waitcnt lgkmcnt(0)
    s_add_u32 m0, s79, 0
    s_nop 0
    buffer_load_dwordx4 v[150:151], s[60:63], s78 idxen offen sc1 lds
    s_add_u32 m0, s79, 1024
    s_nop 0
    buffer_load_dwordx4 v[152:153], s[60:63], s78 idxen offen sc1 lds
    s_add_u32 m0, s79, 2048
    s_nop 0
    buffer_load_dwordx4 v[154:155], s[60:63], s78 idxen offen sc1 lds
    s_add_u32 m0, s79, 3072
    s_nop 0
    buffer_load_dwordx4 v[156:157], s[60:63], s78 idxen offen sc1 lds
    s_add_u32 m0, s40, 0
    s_nop 0
    buffer_load_dwordx4 v[4:5], s[28:31], 0 idxen offen lds
    ds_read_b32 v150, v158 offset:256
    ds_read_b32 v152, v158 offset:320
    ds_read_b32 v154, v158 offset:384
    ds_read_b32 v156, v158 offset:448
    ds_read_b32 v4, v3 offset:256
    s_waitcnt lgkmcnt(0)
    s_add_u32 m0, s79, 32768
    s_nop 0
    buffer_load_dwordx4 v[150:151], s[60:63], s78 idxen offen sc1 lds
    s_add_u32 m0, s79, 33792
    s_nop 0
    buffer_load_dwordx4 v[152:153], s[60:63], s78 idxen offen sc1 lds
    s_add_u32 m0, s79, 34816
    s_nop 0
    buffer_load_dwordx4 v[154:155], s[60:63], s78 idxen offen sc1 lds
    s_add_u32 m0, s79, 35840
    s_nop 0
    buffer_load_dwordx4 v[156:157], s[60:63], s78 idxen offen sc1 lds
    s_add_u32 m0, s40, 1024
    s_nop 0
    buffer_load_dwordx4 v[4:5], s[28:31], 0 idxen offen lds
    s_waitcnt vmcnt(0)
    s_branch L_run
.section .rodata,"a"
.p2align 6
.amdhsa_kernel standalone__mpnn_edge_mlp__graph_kernel
  .amdhsa_next_free_vgpr 256
  .amdhsa_next_free_sgpr 102
  .amdhsa_accum_offset 256
  .amdhsa_group_segment_fixed_size 0
  .amdhsa_kernarg_size 72
  .amdhsa_user_sgpr_count 2
  .amdhsa_user_sgpr_kernarg_segment_ptr 1
  .amdhsa_system_sgpr_workgroup_id_x 1
.end_amdhsa_kernel
```
